```python
import torch

def _softmax(x, axis=-1):
    return torch.softmax(x, dim=axis)
def _gelu(x):
    return torch.nn.functional.gelu(x, approximate="tanh")
def _silu(x):
    return torch.nn.functional.silu(x)
def _sigmoid(x):
    return torch.sigmoid(x)
def _layernorm(x, axis=-1, eps=1e-5):
    m = x.mean(dim=axis, keepdim=True)
    v = x.var(dim=axis, keepdim=True, unbiased=False)
    return (x - m) / torch.sqrt(v + eps)
def _scatter_add(tgt, idx, src, axis=0):
    return tgt.clone().index_add_(axis, idx, src)
def _segment_sum(src, seg, n):
    out = torch.zeros((n,) + src.shape[1:], dtype=src.dtype)
    return out.index_add_(0, seg, src)
def _pad(x, pw):
    flat = tuple(v for pair in reversed(pw) for v in pair)
    return torch.nn.functional.pad(x, flat)

kernel_name = 'parallel_sum__sliding_block__moe_arch_mod__prompt'

def setup_inputs():

    _w = (lambda a: (lambda t: t.to(torch.bfloat16) if t.is_floating_point() else t)(torch.as_tensor(a)))
    def _A_setup():
        B, S, D = 1, 2048, 512
        return {
            "x": _w((lambda *s: torch.randn(*s, dtype=torch.bfloat16) * 0.05)(B, S, D)),
            "wqkv": _w((lambda *s: torch.randn(*s, dtype=torch.bfloat16) * 0.05)(D, 3 * D)),
            "wo": _w((lambda *s: torch.randn(*s, dtype=torch.bfloat16) * 0.05)(D, D)),
        }
    _A_in = _A_setup()

    def _B_setup():
        B, S, D, F, C = 1, 2048, 512, 1376, 1
        return {
            "x": _w((lambda *s: torch.randn(*s, dtype=torch.bfloat16) * 0.05)(B, S, D)),
            "w_r": _w((lambda *s: torch.randn(*s, dtype=torch.bfloat16) * 0.05)(D)),
            "w_gate": _w((lambda *s: torch.randn(*s, dtype=torch.bfloat16) * 0.05)(D, F)),
            "w_up": _w((lambda *s: torch.randn(*s, dtype=torch.bfloat16) * 0.05)(D, F)),
            "w_down": _w((lambda *s: torch.randn(*s, dtype=torch.bfloat16) * 0.05)(F, D)),
        }
    _B_in = _B_setup()

    return {
        "A_x": _A_in["x"],
        "A_wqkv": _A_in["wqkv"],
        "A_wo": _A_in["wo"],
        "B_x": _B_in["x"],
        "B_w_r": _B_in["w_r"],
        "B_w_gate": _B_in["w_gate"],
        "B_w_up": _B_in["w_up"],
        "B_w_down": _B_in["w_down"],
    }

def reference(A_x, A_wqkv, A_wo, B_x, B_w_r, B_w_gate, B_w_up, B_w_down):
    def _A_ref(x, wqkv, wo):
        B, S, D = x.shape
        H = 32; Dh = D // H; W = 256
        qkv = (lambda x, *d: x.permute(*d))((x @ wqkv).reshape(B, S, 3, H, Dh), 2, 0, 3, 1, 4)
        q, k, v = qkv[0], qkv[1], qkv[2]
        scores = torch.einsum("bhqd,bhkd->bhqk", q, k) * (Dh ** -0.5)
        idx = torch.arange(S)
        mask = (idx[:, None] - idx[None, :] >= 0) & (idx[:, None] - idx[None, :] < W)
        scores = torch.where(mask[None, None], scores, -1e9)
        p = _softmax(scores, axis=-1)
        o = torch.einsum("bhqk,bhkd->bhqd", p, v)
        return (lambda x, *d: x.permute(*d))(o, 0, 2, 1, 3).reshape(B, S, D) @ wo

    def _B_ref(x, w_r, w_gate, w_up, w_down):
        B, S, D = x.shape
        C = 1
        r = x @ w_r
        idx = torch.argsort(-r, axis=-1)[:, :C]
        idx_e = (lambda x, n, axis: torch.repeat_interleave(x, n, dim=axis))(idx.reshape(B, C, 1), D, axis=2)
        x_sel = (lambda x, i, axis: torch.take_along_dim(x, i, dim=axis))(x, idx_e, axis=1)
        g = _silu(x_sel @ w_gate)
        u = x_sel @ w_up
        y = (g * u) @ w_down
        r_sel = _sigmoid((lambda x, i, axis: torch.take_along_dim(x, i, dim=axis))(r, idx, axis=1))
        y = y * r_sel.reshape(B, C, 1)
        b_off = (torch.arange(B) * S).reshape(B, 1)
        flat_idx = (idx + b_off).reshape(B * C)
        zero = (x * 0.0).reshape(B * S, D)
        upd = _scatter_add(zero, flat_idx, y.reshape(B * C, D), axis=0)
        return x + upd.reshape(B, S, D)

    x = A_x
    xn = _layernorm(x, axis=-1)
    return x + _A_ref(xn, A_wqkv, A_wo) + _B_ref(xn, B_w_r, B_w_gate, B_w_up, B_w_down)
```

```asm
; @launch grid=(256,1,1) block=(512,1,1) lds=163840
.amdgcn_target "amdgcn-amd-amdhsa--gfx950"
.text
.globl parallel_sum__sliding_block__moe_arch_mod__prompt_kernel
.p2align 8
.type parallel_sum__sliding_block__moe_arch_mod__prompt_kernel,@function
parallel_sum__sliding_block__moe_arch_mod__prompt_kernel:
L_start:
  s_cmp_ge_u32 s2, 256
  s_cbranch_scc1 L_exit
  s_load_dwordx2 s[40:41], s[0:1], 0
  s_load_dwordx2 s[44:45], s[0:1], 8
  s_load_dwordx2 s[56:57], s[0:1], 32
  s_load_dwordx2 s[48:49], s[0:1], 80
  v_lshrrev_b32 v2, 6, v0
  v_and_b32 v1, 63, v0
  s_bfe_u32 s20, s2, 0x20001
  s_bfe_u32 s24, s2, 0x30003
  v_readfirstlane_b32 s5, v2
  s_lshl3_add_u32 s3, s20, s24
  s_and_b32 s20, s2, 1
  s_lshr_b32 s24, s2, 6
  s_lshl2_add_u32 s4, s20, s24
  s_lshl3_add_u32 s8, s3, s4
  s_mov_b32 s42, 2097152
  s_mov_b32 s43, 0x20000
  s_cmp_ge_u32 s5, 4
  s_cbranch_scc1 L_lwave
  s_mov_b32 s58, 1024
  s_mov_b32 s59, 0x20000
  v_and_b32 v2, 31, v1
  v_lshlrev_b32 v80, 4, v2
  v_lshrrev_b32 v3, 5, v1
  v_lshl_add_u32 v4, v3, 10, v80
  s_lshl2_add_u32 s20, s8, s5
  s_lshl_b32 s20, s20, 1
  s_lshl_b32 s21, s20, 10
  s_waitcnt lgkmcnt(0)
  buffer_load_dwordx4 v[8:11], v4, s[40:43], s21 offen
  buffer_load_dwordx4 v[12:15], v4, s[40:43], s21 offen offset:512
  buffer_load_dwordx4 v[16:19], v80, s[56:59], 0 offen
  buffer_load_dwordx4 v[20:23], v80, s[56:59], 0 offen offset:512
  s_branch L_cwave
L_lwave:
  s_mov_b32 s46, 1572864
  s_mov_b32 s47, 0x20000
  s_add_u32 s20, s4, s3
  s_and_b32 s20, s20, 3
  s_lshl_b32 s6, s20, 1
  s_sub_u32 s14, s5, 4
  v_lshrrev_b32 v2, 3, v1
  v_and_b32 v3, 7, v1
  v_lshrrev_b32 v4, 1, v2
  v_xor_b32 v5, v3, v4
  v_lshlrev_b32 v5, 4, v5
  v_lshl_add_u32 v80, v2, 10, v5
  v_xor_b32 v5, 64, v5
  v_lshl_add_u32 v81, v2, 10, v5
  v_add_u32 v81, 7168, v81
  v_and_b32 v4, 1, v4
  v_lshlrev_b32 v4, 2, v4
  v_xor_b32 v5, v3, v4
  v_lshlrev_b32 v84, 4, v5
  v_mul_u32_u24 v82, 3072, v2
  v_add_u32 v82, v82, v84
  v_add_u32 v83, 22528, v82
  s_lshl_b32 s10, s3, 16
  s_lshl_b32 s20, s14, 14
  s_add_u32 s10, s10, s20
  s_lshl_b32 s11, s4, 7
  s_mul_i32 s20, s14, 49152
  s_add_u32 s11, s11, s20
  s_lshl_b32 s31, s14, 11
  s_lshl_b32 s32, s14, 12
  s_waitcnt lgkmcnt(0)
  s_add_u32 s33, s6, 0
  s_and_b32 s33, s33, 7
  s_lshl_b32 s34, s33, 7
  s_add_u32 m0, s31, 0
  s_add_u32 s34, s34, s10
  buffer_load_dwordx4 v80, s[40:43], s34 offen lds
  buffer_load_dwordx4 v81, s[40:43], s34 offen offset:1024 lds
  s_add_u32 s33, s6, 0
  s_and_b32 s33, s33, 7
  s_mul_i32 s35, s33, 196608
  s_add_u32 s35, s35, s11
  s_add_u32 m0, s32, 98304
  s_add_u32 s35, s35, 1024
  buffer_load_dwordx4 v82, s[44:47], s35 offen lds
  buffer_load_dwordx4 v82, s[44:47], s35 offen offset:1024 lds
  buffer_load_dwordx4 v83, s[44:47], s35 offen offset:2048 lds
  buffer_load_dwordx4 v83, s[44:47], s35 offen offset:3072 lds
  s_getpc_b64 s[22:23]
  s_lshr_b32 s20, s2, 3
  s_lshl2_add_u32 s20, s20, s14
  s_lshl_b32 s20, s20, 8
  s_min_u32 s20, s20, 0x6980
  s_add_u32 s22, s22, s20
  s_addc_u32 s23, s23, 0
  s_load_dword s100, s[22:23], 0
  s_load_dword s100, s[22:23], 64
  s_load_dword s100, s[22:23], 128
  s_load_dword s100, s[22:23], 192
  s_add_u32 s33, s6, 1
  s_and_b32 s33, s33, 7
  s_lshl_b32 s34, s33, 7
  s_add_u32 m0, s31, 8192
  s_add_u32 s34, s34, s10
  buffer_load_dwordx4 v80, s[40:43], s34 offen lds
  buffer_load_dwordx4 v81, s[40:43], s34 offen offset:1024 lds
  s_add_u32 s33, s6, 1
  s_and_b32 s33, s33, 7
  s_mul_i32 s35, s33, 196608
  s_add_u32 s35, s35, s11
  s_add_u32 m0, s32, 114688
  s_add_u32 s35, s35, 1024
  buffer_load_dwordx4 v82, s[44:47], s35 offen lds
  buffer_load_dwordx4 v82, s[44:47], s35 offen offset:1024 lds
  buffer_load_dwordx4 v83, s[44:47], s35 offen offset:2048 lds
  buffer_load_dwordx4 v83, s[44:47], s35 offen offset:3072 lds
  s_add_u32 s33, s6, 2
  s_and_b32 s33, s33, 7
  s_lshl_b32 s34, s33, 7
  s_add_u32 m0, s31, 16384
  s_add_u32 s34, s34, s10
  buffer_load_dwordx4 v80, s[40:43], s34 offen lds
  buffer_load_dwordx4 v81, s[40:43], s34 offen offset:1024 lds
  s_add_u32 s33, s6, 2
  s_and_b32 s33, s33, 7
  s_mul_i32 s35, s33, 196608
  s_add_u32 s35, s35, s11
  s_add_u32 m0, s32, 131072
  s_add_u32 s35, s35, 1024
  buffer_load_dwordx4 v82, s[44:47], s35 offen lds
  buffer_load_dwordx4 v82, s[44:47], s35 offen offset:1024 lds
  buffer_load_dwordx4 v83, s[44:47], s35 offen offset:2048 lds
  buffer_load_dwordx4 v83, s[44:47], s35 offen offset:3072 lds
  s_load_dwordx2 s[60:61], s[0:1], 16
  s_load_dwordx2 s[68:69], s[0:1], 40
  s_load_dwordx2 s[72:73], s[0:1], 48
  s_load_dwordx2 s[76:77], s[0:1], 56
  s_load_dwordx2 s[64:65], s[0:1], 64
  s_sub_u32 s89, s8, 80
  s_cmp_ge_u32 s5, 4
  s_cselect_b32 s26, 43, 0
  s_cselect_b32 s24, 0, 43
  s_add_u32 s85, s8, s24
  s_cmp_lt_u32 s8, s26
  s_cselect_b32 s85, s85, 255
  s_mov_b32 s88, 0
  s_and_b32 s12, s14, 1
  s_lshr_b32 s28, s14, 1
  s_lshl_b32 s28, s28, 12
  s_mov_b32 s29, 65536
  s_mov_b32 s15, 0
  v_lshlrev_b32 v85, 4, v1
  s_lshl_b32 s30, s3, 10
  s_add_u32 s30, s30, 32768
  s_cmp_lg_u32 s14, 0
  s_cselect_b32 s30, 0x40000000, s30
  s_mov_b32 s36, 0
  s_cmp_lg_u32 s14, 1
  s_cselect_b32 s36, 0x40000000, s36
  s_lshl2_add_u32 s20, s14, 155872
  v_mov_b32 v198, s20
  v_mov_b32 v199, 155872
  v_mov_b32 v2, 0
  ds_write_b32 v198, v2
  s_sub_u32 s20, 3, s15
  s_cmp_eq_u32 s15, 0
  s_cselect_b32 s21, 4, 1
  s_sub_u32 s22, s3, s20
  s_lshl_b32 s22, s22, 3
  s_add_u32 s22, s22, s4
  s_cmp_ge_u32 s3, s20
  s_cselect_b32 s16, -1, 0
  s_cselect_b32 s22, s22, 0x10000
  s_sub_u32 s23, s3, s21
  s_lshl_b32 s23, s23, 3
  s_add_u32 s23, s23, s4
  s_cmp_ge_u32 s3, s21
  s_cselect_b32 s17, -1, 0
  s_cselect_b32 s23, s23, 0x10000
  s_lshl_b32 s90, s22, 14
  s_add_u32 s90, s90, 1048576
  s_add_u32 s91, s90, 4096
  s_lshl_b32 s92, s23, 14
  s_add_u32 s92, s92, 1048576
  s_add_u32 s93, s92, 4096
  s_lshl_b32 s94, s22, 12
  s_add_u32 s94, s94, 5242880
  s_lshl_b32 s95, s23, 12
  s_add_u32 s95, s95, 5242880
  s_lshl_b32 s82, s5, 16
  s_and_b32 s20, s4, 3
  s_lshl_b32 s20, s20, 8
  s_add_u32 s82, s82, s20
  s_xor_b32 s83, s5, 4
  s_lshl_b32 s83, s83, 14
  s_mov_b32 s13, s3
  s_add_u32 s84, s3, 4
  s_lshl_b32 s81, s3, 1
  s_lshr_b32 s21, s4, 2
  s_add_u32 s81, s81, s21
  s_lshl_b32 s80, s81, 15
  s_add_u32 s80, s80, s20
  s_lshl_b32 s20, s14, 6
  s_add_u32 s80, s80, s20
  s_mov_b32 s78, 1409024
  s_mov_b32 s79, 0x20000
  s_mov_b32 s66, 2097152
  s_mov_b32 s67, 0x20000
  s_mov_b32 s62, 524288
  s_mov_b32 s63, 0x20000
  s_mov_b32 s50, 16777216
  s_mov_b32 s51, 0x20000
  s_waitcnt vmcnt(12)
  s_barrier
  s_add_u32 s33, s6, 3
  s_and_b32 s33, s33, 7
  s_lshl_b32 s34, s33, 7
  s_add_u32 m0, s31, 24576
  s_add_u32 s34, s34, s10
  buffer_load_dwordx4 v80, s[40:43], s34 offen lds
  buffer_load_dwordx4 v81, s[40:43], s34 offen offset:1024 lds
  s_add_u32 s33, s6, 3
  s_and_b32 s33, s33, 7
  s_mul_i32 s35, s33, 196608
  s_add_u32 s35, s35, s11
  s_add_u32 m0, s32, 65536
  s_add_u32 s35, s35, 1024
  buffer_load_dwordx4 v82, s[44:47], s35 offen lds
  buffer_load_dwordx4 v82, s[44:47], s35 offen offset:1024 lds
  buffer_load_dwordx4 v83, s[44:47], s35 offen offset:2048 lds
  buffer_load_dwordx4 v83, s[44:47], s35 offen offset:3072 lds
  v_and_b32 v2, 31, v1
  v_lshrrev_b32 v3, 5, v1
  v_bfe_u32 v4, v2, 1, 3
  v_xor_b32 v4, v4, v3
  v_lshlrev_b32 v4, 4, v4
  v_lshl_add_u32 v4, v2, 7, v4
  v_add_u32 v88, s28, v4
  v_xor_b32 v89, 32, v88
  v_xor_b32 v90, 64, v88
  v_xor_b32 v91, 96, v88
  v_bfe_u32 v4, v1, 2, 2
  v_lshlrev_b32 v4, 7, v4
  v_lshl_add_u32 v4, v3, 11, v4
  v_bfe_u32 v5, v1, 3, 1
  v_lshl_add_u32 v4, v5, 6, v4
  v_bfe_u32 v5, v1, 4, 1
  v_lshl_add_u32 v4, v5, 5, v4
  v_and_b32 v5, 3, v1
  v_lshl_add_u32 v245, v5, 3, v4
  s_lshl_b32 s20, s12, 6
  v_xor_b32 v4, s20, v245
  s_waitcnt vmcnt(12)
  s_barrier
  s_add_u32 s33, s6, 4
  s_and_b32 s33, s33, 7
  s_lshl_b32 s34, s33, 7
  s_add_u32 m0, s31, 32768
  s_add_u32 s34, s34, s10
  buffer_load_dwordx4 v80, s[40:43], s34 offen lds
  buffer_load_dwordx4 v81, s[40:43], s34 offen offset:1024 lds
  s_add_u32 s33, s6, 4
  s_and_b32 s33, s33, 7
  s_mul_i32 s35, s33, 196608
  s_add_u32 s35, s35, s11
  s_add_u32 m0, s32, 81920
  s_add_u32 s35, s35, 1024
  buffer_load_dwordx4 v82, s[44:47], s35 offen lds
  buffer_load_dwordx4 v82, s[44:47], s35 offen offset:1024 lds
  buffer_load_dwordx4 v83, s[44:47], s35 offen offset:2048 lds
  buffer_load_dwordx4 v83, s[44:47], s35 offen offset:3072 lds
  v_add_u32 v92, s29, v4
  v_add_u32 v93, 49152, v92
  v_lshrrev_b32 v4, 4, v1
  v_xor_b32 v4, v4, v1
  v_and_b32 v4, 1, v4
  v_add_u32 v4, -1, v4
  v_and_b32 v204, 0x3f803f80, v4
  v_mov_b32 v205, v204
  v_mov_b32 v206, v204
  v_mov_b32 v207, v204
  v_mov_b32 v200, 0
  v_mov_b32 v201, 0
  v_mov_b32 v202, 0
  v_mov_b32 v203, 0
  s_lshl_b32 s20, s14, 10
  v_lshlrev_b32 v242, 4, v1
  s_lshl_b32 s21, s5, 12
  s_add_u32 s21, s21, 131072
  v_add_u32 v246, s21, v242
  v_add_u32 v242, s20, v242
  v_lshrrev_b32 v244, 1, v242
  v_add_u32 v243, 8192, v242
  s_waitcnt vmcnt(12)
  s_barrier
  s_add_u32 s33, s6, 5
  s_and_b32 s33, s33, 7
  s_lshl_b32 s34, s33, 7
  s_add_u32 m0, s31, 40960
  s_add_u32 s34, s34, s10
  buffer_load_dwordx4 v80, s[40:43], s34 offen lds
  buffer_load_dwordx4 v81, s[40:43], s34 offen offset:1024 lds
  s_add_u32 s33, s6, 5
  s_and_b32 s33, s33, 7
  s_mul_i32 s35, s33, 196608
  s_add_u32 s35, s35, s11
  s_add_u32 m0, s32, 98304
  s_add_u32 s35, s35, 1024
  buffer_load_dwordx4 v82, s[44:47], s35 offen lds
  buffer_load_dwordx4 v82, s[44:47], s35 offen offset:1024 lds
  buffer_load_dwordx4 v83, s[44:47], s35 offen offset:2048 lds
  buffer_load_dwordx4 v83, s[44:47], s35 offen offset:3072 lds
  v_lshrrev_b32 v2, 4, v1
  v_and_b32 v3, 15, v1
  v_lshlrev_b32 v4, 2, v2
  v_xor_b32 v3, v3, v4
  v_lshlrev_b32 v3, 4, v3
  v_lshl_add_u32 v250, v2, 10, v3
  v_add_u32 v251, 3072, v250
  v_add_u32 v252, 6144, v250
  v_add_u32 v253, 9216, v250
  v_and_b32 v3, 31, v1
  v_lshrrev_b32 v4, 5, v1
  v_lshlrev_b32 v247, 10, v3
  v_lshl_add_u32 v247, v4, 4, v247
  v_mul_u32_u24 v4, 22528, v4
  v_lshl_add_u32 v255, v3, 4, v4
  v_mov_b32 v240, 0
  v_mov_b32 v241, 0
  v_mov_b32 v16, 0x3f803f80
  v_mov_b32 v17, v16
  v_mov_b32 v18, v16
  v_mov_b32 v19, v16
  v_mov_b32 v28, v16
  s_waitcnt vmcnt(12)
  s_barrier
  s_add_u32 s33, s6, 6
  s_and_b32 s33, s33, 7
  s_lshl_b32 s34, s33, 7
  s_add_u32 m0, s31, 49152
  s_add_u32 s34, s34, s10
  buffer_load_dwordx4 v80, s[40:43], s34 offen lds
  buffer_load_dwordx4 v81, s[40:43], s34 offen offset:1024 lds
  s_add_u32 s33, s6, 6
  s_and_b32 s33, s33, 7
  s_mul_i32 s35, s33, 196608
  s_add_u32 s35, s35, s11
  s_add_u32 m0, s32, 114688
  s_add_u32 s35, s35, 1024
  buffer_load_dwordx4 v82, s[44:47], s35 offen lds
  buffer_load_dwordx4 v82, s[44:47], s35 offen offset:1024 lds
  buffer_load_dwordx4 v83, s[44:47], s35 offen offset:2048 lds
  buffer_load_dwordx4 v83, s[44:47], s35 offen offset:3072 lds
  v_mov_b32 v29, v16
  v_mov_b32 v30, v16
  v_mov_b32 v31, v16
  v_mov_b32 v40, v16
  v_mov_b32 v41, v16
  v_mov_b32 v42, v16
  v_mov_b32 v43, v16
  v_mov_b32 v52, v16
  v_mov_b32 v53, v16
  v_mov_b32 v54, v16
  v_mov_b32 v55, v16
  v_mov_b32 v64, v16
  v_mov_b32 v65, v16
  v_mov_b32 v66, v16
  v_mov_b32 v67, v16
  v_mov_b32 v76, v16
  v_mov_b32 v77, v16
  v_mov_b32 v78, v16
  v_mov_b32 v79, v16
  v_and_b32 v2, 31, v1
  v_lshrrev_b32 v3, 5, v1
  s_waitcnt vmcnt(12)
  s_barrier
  buffer_load_dwordx4 v[112:115], v85, s[48:51], s30 offen sc1
  s_add_u32 s33, s6, 7
  s_and_b32 s33, s33, 7
  s_lshl_b32 s34, s33, 7
  s_add_u32 m0, s31, 57344
  s_add_u32 s34, s34, s10
  buffer_load_dwordx4 v80, s[40:43], s34 offen lds
  buffer_load_dwordx4 v81, s[40:43], s34 offen offset:1024 lds
  s_add_u32 s33, s6, 7
  s_and_b32 s33, s33, 7
  s_mul_i32 s35, s33, 196608
  s_add_u32 s35, s35, s11
  s_add_u32 m0, s32, 131072
  s_add_u32 s35, s35, 1024
  buffer_load_dwordx4 v82, s[44:47], s35 offen lds
  buffer_load_dwordx4 v82, s[44:47], s35 offen offset:1024 lds
  buffer_load_dwordx4 v83, s[44:47], s35 offen offset:2048 lds
  buffer_load_dwordx4 v83, s[44:47], s35 offen offset:3072 lds
  v_lshlrev_b32 v3, 2, v3
  v_sub_u32 v2, v2, v3
  v_mov_b32 v192, -1
  v_mov_b32 v193, -1
  v_add_u32 v3, 1, v2
  v_med3_i32 v3, v3, 0, 2
  v_lshlrev_b32 v3, 4, v3
  v_lshlrev_b64 v[194:195], v3, v[192:193]
  v_mov_b32 v232, v194
  v_add_u32 v3, -1, v2
  v_med3_i32 v3, v3, 0, 2
  v_lshlrev_b32 v3, 4, v3
  v_lshlrev_b64 v[194:195], v3, v[192:193]
  v_mov_b32 v233, v194
  v_add_u32 v3, -7, v2
  v_med3_i32 v3, v3, 0, 2
  v_lshlrev_b32 v3, 4, v3
  v_lshlrev_b64 v[194:195], v3, v[192:193]
  v_mov_b32 v234, v194
  v_add_u32 v3, -9, v2
  v_med3_i32 v3, v3, 0, 2
  v_lshlrev_b32 v3, 4, v3
  s_waitcnt vmcnt(13)
  s_barrier
  s_add_u32 s33, s6, 0
  s_and_b32 s33, s33, 7
  s_mul_i32 s35, s33, 196608
  s_add_u32 m0, s32, 65536
  s_add_u32 s35, s35, s11
  buffer_load_dwordx4 v82, s[44:47], s35 offen lds
  buffer_load_dwordx4 v83, s[44:47], s35 offen offset:2048 lds
  s_add_u32 s33, s6, 1
  s_and_b32 s33, s33, 7
  s_mul_i32 s35, s33, 196608
  s_add_u32 m0, s32, 66560
  s_add_u32 s35, s35, s11
  buffer_load_dwordx4 v82, s[44:47], s35 offen lds
  buffer_load_dwordx4 v83, s[44:47], s35 offen offset:2048 lds
  s_add_u32 s33, s6, 2
  s_and_b32 s33, s33, 7
  s_mul_i32 s35, s33, 196608
  s_add_u32 m0, s32, 81920
  s_add_u32 s35, s35, s11
  buffer_load_dwordx4 v82, s[44:47], s35 offen lds
  buffer_load_dwordx4 v83, s[44:47], s35 offen offset:2048 lds
  s_add_u32 s33, s6, 3
  s_and_b32 s33, s33, 7
  s_mul_i32 s35, s33, 196608
  s_add_u32 m0, s32, 82944
  s_add_u32 s35, s35, s11
  buffer_load_dwordx4 v82, s[44:47], s35 offen lds
  buffer_load_dwordx4 v83, s[44:47], s35 offen offset:2048 lds
  v_mov_b32 v122, 155776
  ds_read_b32 v123, v122
  v_lshlrev_b64 v[194:195], v3, v[192:193]
  v_mov_b32 v235, v194
  v_add_u32 v3, -15, v2
  v_med3_i32 v3, v3, 0, 2
  v_lshlrev_b32 v3, 4, v3
  v_lshlrev_b64 v[194:195], v3, v[192:193]
  v_mov_b32 v236, v194
  v_add_u32 v3, -17, v2
  v_med3_i32 v3, v3, 0, 2
  v_lshlrev_b32 v3, 4, v3
  v_lshlrev_b64 v[194:195], v3, v[192:193]
  v_mov_b32 v237, v194
  v_add_u32 v3, -23, v2
  v_med3_i32 v3, v3, 0, 2
  v_lshlrev_b32 v3, 4, v3
  v_lshlrev_b64 v[194:195], v3, v[192:193]
  v_mov_b32 v238, v194
  v_add_u32 v3, -25, v2
  v_med3_i32 v3, v3, 0, 2
  v_lshlrev_b32 v3, 4, v3
  v_lshlrev_b64 v[194:195], v3, v[192:193]
  v_mov_b32 v239, v194
  s_waitcnt vmcnt(15)
  s_barrier
  s_add_u32 s33, s6, 4
  s_and_b32 s33, s33, 7
  s_mul_i32 s35, s33, 196608
  s_add_u32 m0, s32, 98304
  s_add_u32 s35, s35, s11
  buffer_load_dwordx4 v82, s[44:47], s35 offen lds
  buffer_load_dwordx4 v83, s[44:47], s35 offen offset:2048 lds
  s_add_u32 s33, s6, 5
  s_and_b32 s33, s33, 7
  s_mul_i32 s35, s33, 196608
  s_add_u32 m0, s32, 99328
  s_add_u32 s35, s35, s11
  buffer_load_dwordx4 v82, s[44:47], s35 offen lds
  buffer_load_dwordx4 v83, s[44:47], s35 offen offset:2048 lds
  s_waitcnt lgkmcnt(0)
  v_readfirstlane_b32 s7, v123
  s_cmp_lg_u32 s14, 0
  s_cbranch_scc1 L_nsib_1
  s_waitcnt vmcnt(18)
  v_cmp_ne_u32 vcc, s7, v115
  s_cbranch_vccz L_ok_3
L_rt_2:
  buffer_load_dwordx4 v[112:115], v85, s[48:51], s30 offen sc1
  s_waitcnt vmcnt(0)
  v_cmp_ne_u32 vcc, s7, v115
  s_add_u32 s88, s88, 1
  s_cmp_gt_u32 s88, 20000
  s_cbranch_scc1 L_end
  s_cbranch_vccnz L_rt_2
L_ok_3:
  v_lshrrev_b32 v122, 1, v85
  v_lshrrev_b32 v123, 2, v85
  v_add_u32 v122, 155904, v122
  v_add_u32 v123, 156416, v123
  ds_write_b64 v122, v[112:113]
  ds_write_b32 v123, v113
  s_waitcnt lgkmcnt(0)
L_nsib_1:
  s_waitcnt vmcnt(12)
  s_barrier
  s_add_u32 s33, s6, 6
  s_and_b32 s33, s33, 7
  s_mul_i32 s35, s33, 196608
  s_add_u32 m0, s32, 114688
  s_add_u32 s35, s35, s11
  buffer_load_dwordx4 v82, s[44:47], s35 offen lds
  buffer_load_dwordx4 v83, s[44:47], s35 offen offset:2048 lds
  s_add_u32 s33, s6, 7
  s_and_b32 s33, s33, 7
  s_mul_i32 s35, s33, 196608
  s_add_u32 m0, s32, 115712
  s_add_u32 s35, s35, s11
  buffer_load_dwordx4 v82, s[44:47], s35 offen lds
  buffer_load_dwordx4 v83, s[44:47], s35 offen offset:2048 lds
  v_mov_b32 v96, 0
  v_mov_b32 v97, 0
  v_mov_b32 v98, 0
  v_mov_b32 v99, 0
  v_mov_b32 v100, 0
  v_mov_b32 v101, 0
  v_mov_b32 v102, 0
  v_mov_b32 v103, 0
  v_mov_b32 v104, 0
  v_mov_b32 v105, 0
  v_mov_b32 v106, 0
  v_mov_b32 v107, 0
  v_mov_b32 v108, 0
  v_mov_b32 v109, 0
  v_mov_b32 v110, 0
  v_mov_b32 v111, 0
  v_and_b32 v2, 31, v1
  v_lshlrev_b32 v2, 3, v2
  s_lshr_b32 s20, s28, 4
  s_add_u32 s20, s20, 155904
  v_add_u32 v2, s20, v2
  ds_read_b64 v[116:117], v2
  s_waitcnt lgkmcnt(0)
  v_cvt_pk_bf16_f32 v120, -v116, -v116
  v_cvt_pk_bf16_f32 v121, -v116, 0
  v_mov_b32 v122, 0
  v_mov_b32 v123, 0
  v_mul_f32 v118, 0x3eb8aa3b, v117
  v_mov_b32 v126, 0
  v_mov_b32 v127, 0
  s_lshl_b32 s30, s14, 11
  s_add_u32 s30, s30, 147456
  v_lshlrev_b32 v5, 4, v1
  v_add_u32 v5, s30, v5
  s_lshl_b32 s20, s28, 1
  s_lshr_b32 s21, s28, 2
  s_xor_b32 s22, s20, 8192
  s_xor_b32 s23, s21, 1024
  v_add_u32 v192, s22, v88
  v_add_u32 v88, s20, v88
  v_add_u32 v193, s22, v89
  v_add_u32 v89, s20, v89
  v_add_u32 v194, s22, v90
  v_add_u32 v90, s20, v90
  v_add_u32 v195, s22, v91
  v_add_u32 v91, s20, v91
  v_add_u32 v196, s23, v92
  v_add_u32 v197, s23, v93
  v_add_u32 v92, s21, v92
  v_add_u32 v93, s21, v93
  s_lshl_b32 s22, s14, 8
  s_add_u32 s22, s22, 157696
  v_lshl_add_u32 v86, v1, 2, s22
  v_xor_b32 v87, 512, v86
  s_mov_b32 s20, 0xffff0000
  s_mov_b32 s21, 0xffff0000
  s_waitcnt vmcnt(0)
  ds_write_b32 v198, v198
L_qr_4:
  ds_read_b128 v[128:131], v199
  s_waitcnt lgkmcnt(0)
  v_min3_u32 v2, v128, v129, v130
  v_min_u32 v2, v2, v131
  v_cmp_eq_u32 vcc, 0, v2
  s_add_u32 s88, s88, 1
  s_cmp_gt_u32 s88, 20000
  s_cbranch_scc1 L_end
  s_cbranch_vccnz L_qr_4
  ds_read_b128 v[128:131], v88 offset:0
  ds_read_b64_tr_b16 v[132:133], v92 offset:0
  ds_read_b64_tr_b16 v[134:135], v92 offset:512
  ds_read_b128 v[136:139], v89 offset:0
  ds_read_b64_tr_b16 v[140:141], v92 offset:4096
  ds_read_b64_tr_b16 v[142:143], v92 offset:4608
  ds_read_b128 v[144:147], v90 offset:0
  ds_read_b64_tr_b16 v[148:149], v92 offset:8192
  ds_read_b64_tr_b16 v[150:151], v92 offset:8704
  ds_read_b128 v[152:155], v91 offset:0
  ds_read_b64_tr_b16 v[156:157], v92 offset:12288
  ds_read_b64_tr_b16 v[158:159], v92 offset:12800
  s_waitcnt lgkmcnt(9)
  v_mfma_f32_16x16x32_bf16 v[200:203], v[204:207], v[132:135], v[200:203]
  v_mfma_f32_32x32x16_bf16 v[96:111], v[132:135], v[128:131], v[96:111]
  ds_read_b128 v[160:163], v88 offset:16384
  ds_read_b64_tr_b16 v[164:165], v92 offset:16384
  ds_read_b64_tr_b16 v[166:167], v92 offset:16896
  s_waitcnt lgkmcnt(9)
  v_mfma_f32_16x16x32_bf16 v[200:203], v[204:207], v[140:143], v[200:203]
  v_mfma_f32_32x32x16_bf16 v[96:111], v[140:143], v[136:139], v[96:111]
  ds_read_b128 v[168:171], v89 offset:16384
  ds_read_b64_tr_b16 v[172:173], v92 offset:20480
  ds_read_b64_tr_b16 v[174:175], v92 offset:20992
  s_waitcnt lgkmcnt(9)
  v_mfma_f32_16x16x32_bf16 v[200:203], v[204:207], v[148:151], v[200:203]
  v_mfma_f32_32x32x16_bf16 v[96:111], v[148:151], v[144:147], v[96:111]
  ds_read_b128 v[176:179], v90 offset:16384
  ds_read_b64_tr_b16 v[180:181], v92 offset:24576
  ds_read_b64_tr_b16 v[182:183], v92 offset:25088
  s_waitcnt lgkmcnt(9)
  v_mfma_f32_16x16x32_bf16 v[200:203], v[204:207], v[156:159], v[200:203]
  v_mfma_f32_32x32x16_bf16 v[96:111], v[156:159], v[152:155], v[96:111]
  ds_read_b128 v[184:187], v91 offset:16384
  ds_read_b64_tr_b16 v[188:189], v92 offset:28672
  ds_read_b64_tr_b16 v[190:191], v92 offset:29184
  s_waitcnt lgkmcnt(9)
  v_mfma_f32_16x16x32_bf16 v[200:203], v[204:207], v[164:167], v[200:203]
  v_mfma_f32_32x32x16_bf16 v[96:111], v[164:167], v[160:163], v[96:111]
  ds_read_b128 v[128:131], v88 offset:32768
  ds_read_b64_tr_b16 v[132:133], v92 offset:32768
  ds_read_b64_tr_b16 v[134:135], v92 offset:33280
  s_waitcnt lgkmcnt(9)
  v_mfma_f32_16x16x32_bf16 v[200:203], v[204:207], v[172:175], v[200:203]
  v_mfma_f32_32x32x16_bf16 v[96:111], v[172:175], v[168:171], v[96:111]
  ds_read_b128 v[136:139], v89 offset:32768
  ds_read_b64_tr_b16 v[140:141], v92 offset:36864
  ds_read_b64_tr_b16 v[142:143], v92 offset:37376
  s_waitcnt lgkmcnt(9)
  v_mfma_f32_16x16x32_bf16 v[200:203], v[204:207], v[180:183], v[200:203]
  v_mfma_f32_32x32x16_bf16 v[96:111], v[180:183], v[176:179], v[96:111]
  ds_read_b128 v[144:147], v90 offset:32768
  ds_read_b64_tr_b16 v[148:149], v92 offset:40960
  ds_read_b64_tr_b16 v[150:151], v92 offset:41472
  s_waitcnt lgkmcnt(9)
  v_mfma_f32_16x16x32_bf16 v[200:203], v[204:207], v[188:191], v[200:203]
  v_mfma_f32_32x32x16_bf16 v[96:111], v[188:191], v[184:187], v[96:111]
  ds_read_b128 v[152:155], v91 offset:32768
  ds_read_b64_tr_b16 v[156:157], v92 offset:45056
  ds_read_b64_tr_b16 v[158:159], v92 offset:45568
  s_waitcnt lgkmcnt(9)
  v_mfma_f32_16x16x32_bf16 v[200:203], v[204:207], v[132:135], v[200:203]
  v_mfma_f32_32x32x16_bf16 v[96:111], v[132:135], v[128:131], v[96:111]
  ds_read_b128 v[160:163], v88 offset:49152
  ds_read_b64_tr_b16 v[164:165], v93 offset:0
  ds_read_b64_tr_b16 v[166:167], v93 offset:512
  s_waitcnt lgkmcnt(9)
  v_mfma_f32_16x16x32_bf16 v[200:203], v[204:207], v[140:143], v[200:203]
  v_mfma_f32_32x32x16_bf16 v[96:111], v[140:143], v[136:139], v[96:111]
  ds_read_b128 v[168:171], v89 offset:49152
  ds_read_b64_tr_b16 v[172:173], v93 offset:4096
  ds_read_b64_tr_b16 v[174:175], v93 offset:4608
  s_waitcnt lgkmcnt(9)
  v_mfma_f32_16x16x32_bf16 v[200:203], v[204:207], v[148:151], v[200:203]
  v_mfma_f32_32x32x16_bf16 v[96:111], v[148:151], v[144:147], v[96:111]
  ds_read_b128 v[176:179], v90 offset:49152
  ds_read_b64_tr_b16 v[180:181], v93 offset:8192
  ds_read_b64_tr_b16 v[182:183], v93 offset:8704
  s_waitcnt lgkmcnt(9)
  v_mfma_f32_16x16x32_bf16 v[200:203], v[204:207], v[156:159], v[200:203]
  v_mfma_f32_32x32x16_bf16 v[96:111], v[156:159], v[152:155], v[96:111]
  ds_read_b128 v[184:187], v91 offset:49152
  ds_read_b64_tr_b16 v[188:189], v93 offset:12288
  ds_read_b64_tr_b16 v[190:191], v93 offset:12800
  s_waitcnt lgkmcnt(9)
  v_mfma_f32_16x16x32_bf16 v[200:203], v[204:207], v[164:167], v[200:203]
  v_mfma_f32_32x32x16_bf16 v[96:111], v[164:167], v[160:163], v[96:111]
  ds_read_b128 v[128:131], v192 offset:0
  ds_read_b64_tr_b16 v[132:133], v196 offset:0
  ds_read_b64_tr_b16 v[134:135], v196 offset:512
  s_waitcnt lgkmcnt(9)
  v_mfma_f32_16x16x32_bf16 v[200:203], v[204:207], v[172:175], v[200:203]
  v_mfma_f32_32x32x16_bf16 v[96:111], v[172:175], v[168:171], v[96:111]
  ds_read_b128 v[136:139], v193 offset:0
  ds_read_b64_tr_b16 v[140:141], v196 offset:4096
  ds_read_b64_tr_b16 v[142:143], v196 offset:4608
  s_waitcnt lgkmcnt(9)
  v_mfma_f32_16x16x32_bf16 v[200:203], v[204:207], v[180:183], v[200:203]
  v_mfma_f32_32x32x16_bf16 v[96:111], v[180:183], v[176:179], v[96:111]
  ds_read_b128 v[144:147], v194 offset:0
  ds_read_b64_tr_b16 v[148:149], v196 offset:8192
  ds_read_b64_tr_b16 v[150:151], v196 offset:8704
  s_waitcnt lgkmcnt(9)
  v_mfma_f32_16x16x32_bf16 v[200:203], v[204:207], v[188:191], v[200:203]
  v_mfma_f32_32x32x16_bf16 v[96:111], v[188:191], v[184:187], v[96:111]
  ds_read_b128 v[152:155], v195 offset:0
  ds_read_b64_tr_b16 v[156:157], v196 offset:12288
  ds_read_b64_tr_b16 v[158:159], v196 offset:12800
  s_waitcnt lgkmcnt(9)
  v_mfma_f32_32x32x16_bf16 v[96:111], v[132:135], v[128:131], v[96:111]
  ds_read_b128 v[160:163], v192 offset:16384
  ds_read_b64_tr_b16 v[164:165], v196 offset:16384
  ds_read_b64_tr_b16 v[166:167], v196 offset:16896
  s_waitcnt lgkmcnt(9)
  v_mfma_f32_32x32x16_bf16 v[96:111], v[140:143], v[136:139], v[96:111]
  ds_read_b128 v[168:171], v193 offset:16384
  ds_read_b64_tr_b16 v[172:173], v196 offset:20480
  ds_read_b64_tr_b16 v[174:175], v196 offset:20992
  v_cndmask_b32_e64 v2, v200, v201, s[20:21]
  ds_write_b32 v86, v2
  s_waitcnt lgkmcnt(10)
  v_mfma_f32_32x32x16_bf16 v[96:111], v[148:151], v[144:147], v[96:111]
  ds_read_b128 v[176:179], v194 offset:16384
  ds_read_b64_tr_b16 v[180:181], v196 offset:24576
  ds_read_b64_tr_b16 v[182:183], v196 offset:25088
  s_waitcnt lgkmcnt(10)
  v_mfma_f32_32x32x16_bf16 v[96:111], v[156:159], v[152:155], v[96:111]
  ds_read_b128 v[184:187], v195 offset:16384
  ds_read_b64_tr_b16 v[188:189], v196 offset:28672
  ds_read_b64_tr_b16 v[190:191], v196 offset:29184
  s_waitcnt lgkmcnt(10)
  v_mfma_f32_32x32x16_bf16 v[96:111], v[164:167], v[160:163], v[96:111]
  ds_read_b128 v[128:131], v192 offset:32768
  ds_read_b64_tr_b16 v[132:133], v196 offset:32768
  ds_read_b64_tr_b16 v[134:135], v196 offset:33280
  s_waitcnt lgkmcnt(10)
  v_mfma_f32_32x32x16_bf16 v[96:111], v[172:175], v[168:171], v[96:111]
  ds_read_b128 v[136:139], v193 offset:32768
  ds_read_b64_tr_b16 v[140:141], v196 offset:36864
  ds_read_b64_tr_b16 v[142:143], v196 offset:37376
  s_waitcnt lgkmcnt(12)
  s_barrier
  ds_read_b32 v4, v87
  s_waitcnt lgkmcnt(10)
  v_mfma_f32_32x32x16_bf16 v[96:111], v[180:183], v[176:179], v[96:111]
  ds_read_b128 v[144:147], v194 offset:32768
  ds_read_b64_tr_b16 v[148:149], v196 offset:40960
  ds_read_b64_tr_b16 v[150:151], v196 offset:41472
  s_waitcnt lgkmcnt(10)
  v_mfma_f32_32x32x16_bf16 v[96:111], v[188:191], v[184:187], v[96:111]
  ds_read_b128 v[152:155], v195 offset:32768
  ds_read_b64_tr_b16 v[156:157], v196 offset:45056
  ds_read_b64_tr_b16 v[158:159], v196 offset:45568
  s_waitcnt lgkmcnt(10)
  v_mfma_f32_32x32x16_bf16 v[96:111], v[132:135], v[128:131], v[96:111]
  ds_read_b128 v[160:163], v192 offset:49152
  ds_read_b64_tr_b16 v[164:165], v197 offset:0
  ds_read_b64_tr_b16 v[166:167], v197 offset:512
  s_waitcnt lgkmcnt(10)
  v_mfma_f32_32x32x16_bf16 v[96:111], v[140:143], v[136:139], v[96:111]
  ds_read_b128 v[168:171], v193 offset:49152
  ds_read_b64_tr_b16 v[172:173], v197 offset:4096
  ds_read_b64_tr_b16 v[174:175], v197 offset:4608
  s_waitcnt lgkmcnt(12)
  v_add_f32 v2, v2, v4
  v_mul_f32 v2, 0.5, v2
  v_cvt_pk_bf16_f32 v3, v2, v2
  v_and_b32 v3, 0xffff0000, v3
  v_sub_f32 v2, v2, v3
  s_waitcnt lgkmcnt(9)
  v_mfma_f32_32x32x16_bf16 v[96:111], v[148:151], v[144:147], v[96:111]
  ds_read_b128 v[176:179], v194 offset:49152
  ds_read_b64_tr_b16 v[180:181], v197 offset:8192
  ds_read_b64_tr_b16 v[182:183], v197 offset:8704
  v_cvt_pk_bf16_f32 v4, v2, v2
  v_and_b32 v4, 0xffff0000, v4
  v_sub_f32 v2, v2, v4
  v_cvt_pk_bf16_f32 v124, v3, v4
  v_cvt_pk_bf16_f32 v125, v2, 0
  s_waitcnt lgkmcnt(9)
  v_mfma_f32_32x32x16_bf16 v[96:111], v[156:159], v[152:155], v[96:111]
  ds_read_b128 v[184:187], v195 offset:49152
  ds_read_b64_tr_b16 v[188:189], v197 offset:12288
  ds_read_b64_tr_b16 v[190:191], v197 offset:12800
  s_waitcnt lgkmcnt(9)
  v_mfma_f32_32x32x16_bf16 v[96:111], v[164:167], v[160:163], v[96:111]
  s_waitcnt lgkmcnt(6)
  v_mfma_f32_32x32x16_bf16 v[96:111], v[172:175], v[168:171], v[96:111]
  s_waitcnt lgkmcnt(3)
  v_mfma_f32_32x32x16_bf16 v[96:111], v[180:183], v[176:179], v[96:111]
  s_waitcnt lgkmcnt(0)
  v_mfma_f32_32x32x16_bf16 v[96:111], v[188:191], v[184:187], v[96:111]
  v_mfma_f32_32x32x16_bf16 v[96:111], v[124:127], v[120:123], v[96:111]
  s_nop 11
  v_mul_f32 v96, v96, v118
  v_mul_f32 v97, v97, v118
  v_mul_f32 v98, v98, v118
  v_mul_f32 v99, v99, v118
  v_mul_f32 v100, v100, v118
  v_mul_f32 v101, v101, v118
  v_mul_f32 v102, v102, v118
  v_mul_f32 v103, v103, v118
  v_mul_f32 v104, v104, v118
  v_mul_f32 v105, v105, v118
  v_mul_f32 v106, v106, v118
  v_mul_f32 v107, v107, v118
  v_mul_f32 v108, v108, v118
  v_mul_f32 v109, v109, v118
  v_mul_f32 v110, v110, v118
  v_mul_f32 v111, v111, v118
  v_cvt_pk_bf16_f32 v128, v96, v97
  v_cvt_pk_bf16_f32 v129, v98, v99
  v_cvt_pk_bf16_f32 v130, v100, v101
  v_cvt_pk_bf16_f32 v131, v102, v103
  v_cvt_pk_bf16_f32 v132, v104, v105
  v_cvt_pk_bf16_f32 v133, v106, v107
  v_cvt_pk_bf16_f32 v134, v108, v109
  v_cvt_pk_bf16_f32 v135, v110, v111
  ds_write_b128 v5, v[128:131]
  ds_write_b128 v5, v[132:135] offset:1024
  s_branch L_join
L_cwave:
  s_load_dword s7, s[48:49], 16384
  s_load_dwordx2 s[60:61], s[0:1], 16
  s_load_dwordx2 s[68:69], s[0:1], 40
  s_load_dwordx2 s[72:73], s[0:1], 48
  s_load_dwordx2 s[76:77], s[0:1], 56
  s_load_dwordx2 s[64:65], s[0:1], 64
  s_sub_u32 s89, s8, 80
  s_cmp_ge_u32 s5, 4
  s_cselect_b32 s26, 43, 0
  s_cselect_b32 s24, 0, 43
  s_add_u32 s85, s8, s24
  s_cmp_lt_u32 s8, s26
  s_cselect_b32 s85, s85, 255
  s_mov_b32 s88, 0
  s_mov_b32 s70, 1409024
  s_mov_b32 s71, 0x20000
  s_mov_b32 s74, 1409024
  s_mov_b32 s75, 0x20000
  v_mov_b32 v6, 0
  v_add_u32 v62, s20, v3
  s_and_b32 s12, s5, 1
  s_mov_b32 s28, 0
  s_lshr_b32 s29, s5, 1
  s_lshl_b32 s29, s29, 10
  s_add_u32 s29, s29, 65536
  s_mov_b32 s14, s5
  s_mov_b32 s15, 1
  v_lshlrev_b32 v83, 4, v1
  s_lshl_b32 s35, s5, 10
  s_add_u32 s35, s35, 0
  s_lshl_b32 s33, s8, 14
  s_add_u32 s33, s33, 1048576
  s_add_u32 s36, s33, 4096
  s_lshl_b32 s34, s8, 12
  s_add_u32 s34, s34, 5242880
  v_and_b32 v2, 31, v1
  v_lshrrev_b32 v3, 5, v1
  v_bfe_u32 v4, v2, 1, 3
  v_xor_b32 v4, v4, v3
  v_lshlrev_b32 v4, 4, v4
  v_lshl_add_u32 v4, v2, 7, v4
  v_add_u32 v88, s28, v4
  v_xor_b32 v89, 32, v88
  v_xor_b32 v90, 64, v88
  v_xor_b32 v91, 96, v88
  v_bfe_u32 v4, v1, 2, 2
  v_lshlrev_b32 v4, 7, v4
  v_lshl_add_u32 v4, v3, 11, v4
  v_bfe_u32 v5, v1, 3, 1
  v_lshl_add_u32 v4, v5, 6, v4
  v_bfe_u32 v5, v1, 4, 1
  v_lshl_add_u32 v4, v5, 5, v4
  v_and_b32 v5, 3, v1
  v_lshl_add_u32 v245, v5, 3, v4
  s_lshl_b32 s20, s12, 6
  v_xor_b32 v4, s20, v245
  v_add_u32 v92, s29, v4
  v_add_u32 v93, 49152, v92
  v_lshrrev_b32 v4, 4, v1
  v_xor_b32 v4, v4, v1
  v_and_b32 v4, 1, v4
  v_add_u32 v4, -1, v4
  v_and_b32 v204, 0x3f803f80, v4
  v_mov_b32 v205, v204
  v_mov_b32 v206, v204
  v_mov_b32 v207, v204
  v_mov_b32 v200, 0
  v_mov_b32 v201, 0
  v_mov_b32 v202, 0
  v_mov_b32 v203, 0
  s_mov_b32 s50, 16777216
  s_mov_b32 s51, 0x20000
  v_lshrrev_b32 v2, 3, v1
  v_mul_u32_u24 v3, 2752, v2
  v_and_b32 v4, 7, v1
  v_lshl_add_u32 v5, v4, 4, v3
  s_and_b32 s31, s8, 7
  s_lshl_b32 s31, s31, 6
  s_lshl_b32 s32, s5, 4
  s_add_u32 s31, s31, s32
  s_mul_i32 s31, s31, 2752
  s_lshr_b32 s32, s89, 3
  s_lshl_b32 s32, s32, 7
  s_add_u32 s31, s31, s32
  s_cmp_ge_u32 s89, 176
  s_cselect_b32 s31, 0x40000000, s31
  s_add_u32 s32, s31, 22016
  v_mov_b32 v40, 0
  v_mov_b32 v41, 0
  v_mov_b32 v42, 0
  v_mov_b32 v43, 0
  v_mov_b32 v48, 0x3f803f80
  v_sub_u32 v47, 2047, v62
  v_and_b32 v46, 7, v62
  v_lshlrev_b32 v46, 4, v46
  v_add_u32 v46, 155648, v46
  s_mov_b32 s26, 0xffff0000
  s_waitcnt vmcnt(2)
  v_dot2_f32_bf16 v40, v8, v48, v40
  v_dot2_f32_bf16 v41, v8, v8, v41
  v_dot2_f32_bf16 v40, v9, v48, v40
  v_dot2_f32_bf16 v41, v9, v9, v41
  v_dot2_f32_bf16 v40, v10, v48, v40
  v_dot2_f32_bf16 v41, v10, v10, v41
  v_dot2_f32_bf16 v40, v11, v48, v40
  v_dot2_f32_bf16 v41, v11, v11, v41
  v_dot2_f32_bf16 v40, v12, v48, v40
  v_dot2_f32_bf16 v41, v12, v12, v41
  v_dot2_f32_bf16 v40, v13, v48, v40
  v_dot2_f32_bf16 v41, v13, v13, v41
  v_dot2_f32_bf16 v40, v14, v48, v40
  v_dot2_f32_bf16 v41, v14, v14, v41
  v_dot2_f32_bf16 v40, v15, v48, v40
  v_dot2_f32_bf16 v41, v15, v15, v41
  s_waitcnt vmcnt(0)
  v_dot2_f32_bf16 v42, v8, v16, v42
  v_dot2_f32_bf16 v43, v16, v48, v43
  v_dot2_f32_bf16 v42, v9, v17, v42
  v_dot2_f32_bf16 v43, v17, v48, v43
  v_dot2_f32_bf16 v42, v10, v18, v42
  v_dot2_f32_bf16 v43, v18, v48, v43
  v_dot2_f32_bf16 v42, v11, v19, v42
  v_dot2_f32_bf16 v43, v19, v48, v43
  v_dot2_f32_bf16 v42, v12, v20, v42
  v_dot2_f32_bf16 v43, v20, v48, v43
  v_dot2_f32_bf16 v42, v13, v21, v42
  v_dot2_f32_bf16 v43, v21, v48, v43
  v_dot2_f32_bf16 v42, v14, v22, v42
  v_dot2_f32_bf16 v43, v22, v48, v43
  v_dot2_f32_bf16 v42, v15, v23, v42
  v_dot2_f32_bf16 v43, v23, v48, v43
  v_add_f32_dpp v40, v40, v40 quad_perm:[1,0,3,2] row_mask:0xf bank_mask:0xf
  v_add_f32_dpp v41, v41, v41 quad_perm:[1,0,3,2] row_mask:0xf bank_mask:0xf
  v_add_f32_dpp v42, v42, v42 quad_perm:[1,0,3,2] row_mask:0xf bank_mask:0xf
  v_add_f32_dpp v43, v43, v43 quad_perm:[1,0,3,2] row_mask:0xf bank_mask:0xf
  v_add_f32_dpp v40, v40, v40 quad_perm:[2,3,0,1] row_mask:0xf bank_mask:0xf
  v_add_f32_dpp v41, v41, v41 quad_perm:[2,3,0,1] row_mask:0xf bank_mask:0xf
  v_add_f32_dpp v42, v42, v42 quad_perm:[2,3,0,1] row_mask:0xf bank_mask:0xf
  v_add_f32_dpp v43, v43, v43 quad_perm:[2,3,0,1] row_mask:0xf bank_mask:0xf
  v_add_f32_dpp v40, v40, v40 row_half_mirror row_mask:0xf bank_mask:0xf
  v_add_f32_dpp v41, v41, v41 row_half_mirror row_mask:0xf bank_mask:0xf
  v_add_f32_dpp v42, v42, v42 row_half_mirror row_mask:0xf bank_mask:0xf
  v_add_f32_dpp v43, v43, v43 row_half_mirror row_mask:0xf bank_mask:0xf
  v_add_f32_dpp v40, v40, v40 row_mirror row_mask:0xf bank_mask:0xf
  v_add_f32_dpp v41, v41, v41 row_mirror row_mask:0xf bank_mask:0xf
  v_add_f32_dpp v42, v42, v42 row_mirror row_mask:0xf bank_mask:0xf
  v_add_f32_dpp v43, v43, v43 row_mirror row_mask:0xf bank_mask:0xf
  v_mov_b32 v24, v40
  v_mov_b32 v25, v41
  v_mov_b32 v26, v42
  v_mov_b32 v27, v43
  v_permlane16_swap_b32 v40, v24
  v_permlane16_swap_b32 v41, v25
  v_permlane16_swap_b32 v42, v26
  v_permlane16_swap_b32 v43, v27
  v_add_f32 v40, v40, v24
  v_add_f32 v41, v41, v25
  v_add_f32 v42, v42, v26
  v_add_f32 v43, v43, v27
  v_mul_f32 v40, 0x3b000000, v40
  v_mul_f32 v41, 0x3b000000, v41
  v_fma_f32 v41, -v40, v40, v41
  v_max_f32 v41, 0, v41
  v_cvt_pk_bf16_f32 v40, v40, v40
  v_and_b32 v40, 0xffff0000, v40
  v_fma_f32 v42, -v40, v43, v42
  v_cvt_pk_bf16_f32 v41, v41, v41
  v_and_b32 v41, 0xffff0000, v41
  v_add_f32 v41, 0x3727c5ac, v41
  v_cvt_pk_bf16_f32 v41, v41, v41
  v_and_b32 v41, 0xffff0000, v41
  v_sqrt_f32 v41, v41
  s_nop 0
  v_cvt_pk_bf16_f32 v41, v41, v41
  v_and_b32 v41, 0xffff0000, v41
  v_rcp_f32 v41, v41
  s_nop 0
  v_mul_f32 v42, v42, v41
  v_cvt_pk_bf16_f32 v42, v42, v42
  v_and_b32 v42, 0xffff0000, v42
  v_ashrrev_i32 v45, 31, v42
  v_or_b32 v45, 0x80000000, v45
  v_xor_b32 v42, v42, v45
  v_and_or_b32 v42, v42, s26, v47
  ds_write_b96 v46, v[40:42]
  s_waitcnt lgkmcnt(0)
  s_add_u32 s7, s7, 1
  v_mov_b32 v44, s7
  v_mov_b32 v45, 155776
  ds_write_b32 v45, v44
  v_mov_b32 v43, s7
  v_lshlrev_b32 v44, 4, v62
  s_mov_b32 s24, 1
  s_mov_b32 s25, 1
  s_mov_b32 s27, 32768
  s_mov_b64 exec, s[24:25]
  buffer_store_dwordx4 v[40:43], v44, s[48:51], s27 offen sc1
  s_mov_b64 exec, -1
  s_setprio 2
  buffer_load_dwordx4 v[208:211], v5, s[68:71], s31 offen nt
  buffer_load_dwordx4 v[212:215], v5, s[72:75], s31 offen nt
  buffer_load_dwordx4 v[216:219], v5, s[68:71], s32 offen nt
  buffer_load_dwordx4 v[220:223], v5, s[72:75], s32 offen nt
  v_mov_b32 v54, v5
  s_waitcnt lgkmcnt(0)
  s_cmp_ge_u32 s5, 2
  s_cbranch_scc1 L_vwave
  s_barrier
  ds_read_b128 v[128:131], v88 offset:0
  ds_read_b128 v[132:135], v88 offset:4096
  ds_read_b64_tr_b16 v[136:137], v92 offset:32768
  ds_read_b64_tr_b16 v[138:139], v92 offset:33280
  ds_read_b128 v[140:143], v89 offset:0
  ds_read_b128 v[144:147], v89 offset:4096
  ds_read_b64_tr_b16 v[148:149], v92 offset:36864
  ds_read_b64_tr_b16 v[150:151], v92 offset:37376
  ds_read_b128 v[152:155], v90 offset:0
  ds_read_b128 v[156:159], v90 offset:4096
  ds_read_b64_tr_b16 v[160:161], v92 offset:40960
  ds_read_b64_tr_b16 v[162:163], v92 offset:41472
  ds_read_b128 v[164:167], v91 offset:0
  ds_read_b128 v[168:171], v91 offset:4096
  ds_read_b64_tr_b16 v[172:173], v92 offset:45056
  ds_read_b64_tr_b16 v[174:175], v92 offset:45568
  s_waitcnt lgkmcnt(12)
  v_mfma_f32_16x16x32_bf16 v[200:203], v[204:207], v[136:139], v[200:203]
  v_and_b32 v53, 0x70, v83
  v_mfma_f32_32x32x16_bf16 v[96:111], v[136:139], v[128:131], 0
  v_add_u32 v53, 155648, v53
  v_mfma_f32_32x32x16_bf16 v[112:127], v[136:139], v[132:135], 0
  s_waitcnt lgkmcnt(8)
  v_mfma_f32_16x16x32_bf16 v[200:203], v[204:207], v[148:151], v[200:203]
  v_mfma_f32_32x32x16_bf16 v[96:111], v[148:151], v[140:143], v[96:111]
  v_mfma_f32_32x32x16_bf16 v[112:127], v[148:151], v[144:147], v[112:127]
  ds_read_b96 v[48:50], v53
  s_waitcnt lgkmcnt(0)
  s_cmp_lg_u32 s5, 0
  s_cbranch_scc1 L_np_5
  v_mov_b32 v51, s7
  s_lshl_b32 s20, s8, 4
  s_add_u32 s20, s20, 0
  s_lshl_b32 s21, s8, 7
  s_add_u32 s21, s21, 32768
  s_mov_b64 exec, 0xff
  v_mov_b32 v52, v50
  s_nop 1
  v_max_u32_dpp v52, v52, v52 quad_perm:[1,0,3,2] row_mask:0xf bank_mask:0xf
  s_nop 1
  v_max_u32_dpp v52, v52, v52 quad_perm:[2,3,0,1] row_mask:0xf bank_mask:0xf
  s_nop 1
  v_max_u32_dpp v52, v52, v52 row_half_mirror row_mask:0xf bank_mask:0xf
  v_cmp_eq_u32 vcc, v52, v50
  s_nop 0
  s_mov_b64 exec, vcc
  buffer_store_dwordx4 v[48:51], v6, s[48:51], s20 offen sc1
  s_mov_b64 exec, -1
L_np_5:
  s_barrier
  ds_read_b128 v[176:179], v88 offset:8192
  ds_read_b128 v[180:183], v88 offset:12288
  ds_read_b64_tr_b16 v[184:185], v93 offset:0
  ds_read_b64_tr_b16 v[186:187], v93 offset:512
  v_mfma_f32_16x16x32_bf16 v[200:203], v[204:207], v[160:163], v[200:203]
  ds_read_b128 v[188:191], v89 offset:8192
  ds_read_b128 v[192:195], v89 offset:12288
  v_mfma_f32_32x32x16_bf16 v[96:111], v[160:163], v[152:155], v[96:111]
  ds_read_b64_tr_b16 v[196:197], v93 offset:4096
  ds_read_b64_tr_b16 v[198:199], v93 offset:4608
  v_mfma_f32_32x32x16_bf16 v[112:127], v[160:163], v[156:159], v[112:127]
  ds_read_b128 v[128:131], v90 offset:8192
  ds_read_b128 v[132:135], v90 offset:12288
  v_mfma_f32_16x16x32_bf16 v[200:203], v[204:207], v[172:175], v[200:203]
  ds_read_b64_tr_b16 v[136:137], v93 offset:8192
  ds_read_b64_tr_b16 v[138:139], v93 offset:8704
  v_mfma_f32_32x32x16_bf16 v[96:111], v[172:175], v[164:167], v[96:111]
  ds_read_b128 v[140:143], v91 offset:8192
  ds_read_b128 v[144:147], v91 offset:12288
  v_mfma_f32_32x32x16_bf16 v[112:127], v[172:175], v[168:171], v[112:127]
  ds_read_b64_tr_b16 v[148:149], v93 offset:12288
  ds_read_b64_tr_b16 v[150:151], v93 offset:12800
  s_waitcnt lgkmcnt(12)
  v_mfma_f32_16x16x32_bf16 v[200:203], v[204:207], v[184:187], v[200:203]
  s_sub_u32 s20, 3, s15
  s_cmp_eq_u32 s15, 0
  s_cselect_b32 s21, 4, 1
  s_sub_u32 s22, s3, s20
  s_lshl_b32 s22, s22, 3
  v_mfma_f32_32x32x16_bf16 v[96:111], v[184:187], v[176:179], v[96:111]
  s_add_u32 s22, s22, s4
  s_cmp_ge_u32 s3, s20
  s_cselect_b32 s16, -1, 0
  s_cselect_b32 s22, s22, 0x10000
  s_sub_u32 s23, s3, s21
  v_mfma_f32_32x32x16_bf16 v[112:127], v[184:187], v[180:183], v[112:127]
  s_lshl_b32 s23, s23, 3
  s_add_u32 s23, s23, s4
  s_cmp_ge_u32 s3, s21
  s_cselect_b32 s17, -1, 0
  s_cselect_b32 s23, s23, 0x10000
  s_waitcnt lgkmcnt(8)
  v_mfma_f32_16x16x32_bf16 v[200:203], v[204:207], v[196:199], v[200:203]
  s_lshl_b32 s90, s22, 14
  s_add_u32 s90, s90, 1048576
  s_add_u32 s91, s90, 4096
  s_lshl_b32 s92, s23, 14
  s_add_u32 s92, s92, 1048576
  v_mfma_f32_32x32x16_bf16 v[96:111], v[196:199], v[188:191], v[96:111]
  s_add_u32 s93, s92, 4096
  s_lshl_b32 s94, s22, 12
  s_add_u32 s94, s94, 5242880
  s_lshl_b32 s95, s23, 12
  s_add_u32 s95, s95, 5242880
  v_mfma_f32_32x32x16_bf16 v[112:127], v[196:199], v[192:195], v[112:127]
  s_waitcnt lgkmcnt(0)
  s_barrier
  ds_read_b128 v[152:155], v88 offset:16384
  ds_read_b128 v[156:159], v88 offset:20480
  ds_read_b64_tr_b16 v[160:161], v93 offset:16384
  ds_read_b64_tr_b16 v[162:163], v93 offset:16896
  v_mfma_f32_16x16x32_bf16 v[200:203], v[204:207], v[136:139], v[200:203]
  ds_read_b128 v[164:167], v89 offset:16384
  ds_read_b128 v[168:171], v89 offset:20480
  v_mfma_f32_32x32x16_bf16 v[96:111], v[136:139], v[128:131], v[96:111]
  ds_read_b64_tr_b16 v[172:173], v93 offset:20480
  ds_read_b64_tr_b16 v[174:175], v93 offset:20992
  v_mfma_f32_32x32x16_bf16 v[112:127], v[136:139], v[132:135], v[112:127]
  ds_read_b128 v[176:179], v90 offset:16384
  ds_read_b128 v[180:183], v90 offset:20480
  v_mfma_f32_16x16x32_bf16 v[200:203], v[204:207], v[148:151], v[200:203]
  ds_read_b64_tr_b16 v[184:185], v93 offset:24576
  ds_read_b64_tr_b16 v[186:187], v93 offset:25088
  v_mfma_f32_32x32x16_bf16 v[96:111], v[148:151], v[140:143], v[96:111]
  ds_read_b128 v[188:191], v91 offset:16384
  ds_read_b128 v[192:195], v91 offset:20480
  v_mfma_f32_32x32x16_bf16 v[112:127], v[148:151], v[144:147], v[112:127]
  ds_read_b64_tr_b16 v[196:197], v93 offset:28672
  ds_read_b64_tr_b16 v[198:199], v93 offset:29184
  s_waitcnt lgkmcnt(12)
  v_mfma_f32_16x16x32_bf16 v[200:203], v[204:207], v[160:163], v[200:203]
  s_lshl_b32 s82, s5, 16
  s_and_b32 s20, s4, 3
  s_lshl_b32 s20, s20, 8
  s_add_u32 s82, s82, s20
  v_mfma_f32_32x32x16_bf16 v[96:111], v[160:163], v[152:155], v[96:111]
  s_xor_b32 s83, s5, 4
  s_lshl_b32 s83, s83, 14
  s_mov_b32 s13, s3
  s_add_u32 s84, s3, 4
  v_mfma_f32_32x32x16_bf16 v[112:127], v[160:163], v[156:159], v[112:127]
  s_lshl_b32 s81, s3, 1
  s_lshr_b32 s21, s4, 2
  s_add_u32 s81, s81, s21
  s_lshl_b32 s80, s81, 15
  s_waitcnt lgkmcnt(8)
  v_mfma_f32_16x16x32_bf16 v[200:203], v[204:207], v[172:175], v[200:203]
  s_add_u32 s80, s80, s20
  s_lshl_b32 s20, s14, 6
  s_add_u32 s80, s80, s20
  s_mov_b32 s78, 1409024
  v_mfma_f32_32x32x16_bf16 v[96:111], v[172:175], v[164:167], v[96:111]
  s_mov_b32 s79, 0x20000
  s_mov_b32 s66, 2097152
  s_mov_b32 s67, 0x20000
  s_mov_b32 s62, 524288
  v_mfma_f32_32x32x16_bf16 v[112:127], v[172:175], v[168:171], v[112:127]
  s_mov_b32 s63, 0x20000
  s_mov_b32 s50, 16777216
  s_mov_b32 s51, 0x20000
  s_waitcnt lgkmcnt(0)
  s_barrier
  ds_read_b128 v[128:131], v88 offset:24576
  ds_read_b128 v[132:135], v88 offset:28672
  ds_read_b64_tr_b16 v[136:137], v92 offset:0
  ds_read_b64_tr_b16 v[138:139], v92 offset:512
  v_mfma_f32_16x16x32_bf16 v[200:203], v[204:207], v[184:187], v[200:203]
  ds_read_b128 v[140:143], v89 offset:24576
  ds_read_b128 v[144:147], v89 offset:28672
  v_mfma_f32_32x32x16_bf16 v[96:111], v[184:187], v[176:179], v[96:111]
  ds_read_b64_tr_b16 v[148:149], v92 offset:4096
  ds_read_b64_tr_b16 v[150:151], v92 offset:4608
  v_mfma_f32_32x32x16_bf16 v[112:127], v[184:187], v[180:183], v[112:127]
  ds_read_b128 v[152:155], v90 offset:24576
  ds_read_b128 v[156:159], v90 offset:28672
  v_mfma_f32_16x16x32_bf16 v[200:203], v[204:207], v[196:199], v[200:203]
  ds_read_b64_tr_b16 v[160:161], v92 offset:8192
  ds_read_b64_tr_b16 v[162:163], v92 offset:8704
  v_mfma_f32_32x32x16_bf16 v[96:111], v[196:199], v[188:191], v[96:111]
  ds_read_b128 v[164:167], v91 offset:24576
  ds_read_b128 v[168:171], v91 offset:28672
  v_mfma_f32_32x32x16_bf16 v[112:127], v[196:199], v[192:195], v[112:127]
  ds_read_b64_tr_b16 v[172:173], v92 offset:12288
  ds_read_b64_tr_b16 v[174:175], v92 offset:12800
  s_waitcnt lgkmcnt(12)
  v_mfma_f32_16x16x32_bf16 v[200:203], v[204:207], v[136:139], v[200:203]
  v_mov_b32 v58, 0
  v_mov_b32 v59, 0
  v_mfma_f32_32x32x16_bf16 v[96:111], v[136:139], v[128:131], v[96:111]
  v_lshrrev_b32 v64, 1, v80
  v_add_u32 v64, 155904, v64
  v_mfma_f32_32x32x16_bf16 v[112:127], v[136:139], v[132:135], v[112:127]
  v_mov_b32 v66, 155776
  s_lshl_b32 s20, s12, 11
  s_waitcnt lgkmcnt(8)
  v_mfma_f32_16x16x32_bf16 v[200:203], v[204:207], v[148:151], v[200:203]
  v_add_u32 v81, s20, v83
  v_lshrrev_b32 v82, 1, v81
  v_mfma_f32_32x32x16_bf16 v[96:111], v[148:151], v[140:143], v[96:111]
  v_mfma_f32_32x32x16_bf16 v[112:127], v[148:151], v[144:147], v[112:127]
  s_waitcnt lgkmcnt(0)
  s_barrier
  ds_read_b128 v[176:179], v88 offset:32768
  ds_read_b128 v[180:183], v88 offset:36864
  ds_read_b64_tr_b16 v[184:185], v92 offset:16384
  ds_read_b64_tr_b16 v[186:187], v92 offset:16896
  v_mfma_f32_16x16x32_bf16 v[200:203], v[204:207], v[160:163], v[200:203]
  ds_read_b128 v[188:191], v89 offset:32768
  ds_read_b128 v[192:195], v89 offset:36864
  v_mfma_f32_32x32x16_bf16 v[96:111], v[160:163], v[152:155], v[96:111]
  ds_read_b64_tr_b16 v[196:197], v92 offset:20480
  ds_read_b64_tr_b16 v[198:199], v92 offset:20992
  v_mfma_f32_32x32x16_bf16 v[112:127], v[160:163], v[156:159], v[112:127]
  ds_read_b128 v[128:131], v90 offset:32768
  ds_read_b128 v[132:135], v90 offset:36864
  v_mfma_f32_16x16x32_bf16 v[200:203], v[204:207], v[172:175], v[200:203]
  ds_read_b64_tr_b16 v[136:137], v92 offset:24576
  ds_read_b64_tr_b16 v[138:139], v92 offset:25088
  v_mfma_f32_32x32x16_bf16 v[96:111], v[172:175], v[164:167], v[96:111]
  ds_read_b128 v[140:143], v91 offset:32768
  ds_read_b128 v[144:147], v91 offset:36864
  v_mfma_f32_32x32x16_bf16 v[112:127], v[172:175], v[168:171], v[112:127]
  ds_read_b64_tr_b16 v[148:149], v92 offset:28672
  ds_read_b64_tr_b16 v[150:151], v92 offset:29184
  s_waitcnt lgkmcnt(12)
  v_mfma_f32_16x16x32_bf16 v[200:203], v[204:207], v[184:187], v[200:203]
  s_lshl_b32 s20, s14, 10
  v_lshlrev_b32 v242, 4, v1
  s_lshl_b32 s21, s5, 12
  s_add_u32 s21, s21, 131072
  v_add_u32 v246, s21, v242
  v_mfma_f32_32x32x16_bf16 v[96:111], v[184:187], v[176:179], v[96:111]
  v_add_u32 v242, s20, v242
  v_lshrrev_b32 v244, 1, v242
  v_add_u32 v243, 8192, v242
  v_lshrrev_b32 v2, 4, v1
  v_and_b32 v3, 15, v1
  v_mfma_f32_32x32x16_bf16 v[112:127], v[184:187], v[180:183], v[112:127]
  v_lshlrev_b32 v4, 2, v2
  v_xor_b32 v3, v3, v4
  v_lshlrev_b32 v3, 4, v3
  v_lshl_add_u32 v250, v2, 10, v3
  v_add_u32 v251, 3072, v250
  s_waitcnt lgkmcnt(8)
  v_mfma_f32_16x16x32_bf16 v[200:203], v[204:207], v[196:199], v[200:203]
  v_add_u32 v252, 6144, v250
  v_add_u32 v253, 9216, v250
  v_and_b32 v3, 31, v1
  v_lshrrev_b32 v4, 5, v1
  v_lshlrev_b32 v247, 10, v3
  v_mfma_f32_32x32x16_bf16 v[96:111], v[196:199], v[188:191], v[96:111]
  v_lshl_add_u32 v247, v4, 4, v247
  v_mul_u32_u24 v4, 22528, v4
  v_lshl_add_u32 v255, v3, 4, v4
  v_mov_b32 v240, 0
  v_mov_b32 v241, 0
  v_mfma_f32_32x32x16_bf16 v[112:127], v[196:199], v[192:195], v[112:127]
  s_waitcnt lgkmcnt(0)
  s_barrier
  ds_read_b128 v[152:155], v88 offset:40960
  ds_read_b128 v[156:159], v88 offset:45056
  ds_read_b64_tr_b16 v[160:161], v92 offset:32768
  ds_read_b64_tr_b16 v[162:163], v92 offset:33280
  v_mfma_f32_16x16x32_bf16 v[200:203], v[204:207], v[136:139], v[200:203]
  ds_read_b128 v[164:167], v89 offset:40960
  ds_read_b128 v[168:171], v89 offset:45056
  v_mfma_f32_32x32x16_bf16 v[96:111], v[136:139], v[128:131], v[96:111]
  ds_read_b64_tr_b16 v[172:173], v92 offset:36864
  ds_read_b64_tr_b16 v[174:175], v92 offset:37376
  v_mfma_f32_32x32x16_bf16 v[112:127], v[136:139], v[132:135], v[112:127]
  ds_read_b128 v[176:179], v90 offset:40960
  ds_read_b128 v[180:183], v90 offset:45056
  v_mfma_f32_16x16x32_bf16 v[200:203], v[204:207], v[148:151], v[200:203]
  ds_read_b64_tr_b16 v[184:185], v92 offset:40960
  ds_read_b64_tr_b16 v[186:187], v92 offset:41472
  v_mfma_f32_32x32x16_bf16 v[96:111], v[148:151], v[140:143], v[96:111]
  ds_read_b128 v[188:191], v91 offset:40960
  ds_read_b128 v[192:195], v91 offset:45056
  v_mfma_f32_32x32x16_bf16 v[112:127], v[148:151], v[144:147], v[112:127]
  ds_read_b64_tr_b16 v[196:197], v92 offset:45056
  ds_read_b64_tr_b16 v[198:199], v92 offset:45568
  s_waitcnt lgkmcnt(12)
  v_mfma_f32_16x16x32_bf16 v[200:203], v[204:207], v[160:163], v[200:203]
  v_mfma_f32_32x32x16_bf16 v[96:111], v[160:163], v[152:155], v[96:111]
  v_mfma_f32_32x32x16_bf16 v[112:127], v[160:163], v[156:159], v[112:127]
  s_waitcnt lgkmcnt(8)
  v_mfma_f32_16x16x32_bf16 v[200:203], v[204:207], v[172:175], v[200:203]
  v_mfma_f32_32x32x16_bf16 v[96:111], v[172:175], v[164:167], v[96:111]
  v_mfma_f32_32x32x16_bf16 v[112:127], v[172:175], v[168:171], v[112:127]
  s_waitcnt lgkmcnt(0)
  s_barrier
  ds_read_b128 v[128:131], v88 offset:49152
  ds_read_b128 v[132:135], v88 offset:53248
  ds_read_b64_tr_b16 v[136:137], v93 offset:0
  ds_read_b64_tr_b16 v[138:139], v93 offset:512
  v_mfma_f32_16x16x32_bf16 v[200:203], v[204:207], v[184:187], v[200:203]
  ds_read_b128 v[140:143], v89 offset:49152
  ds_read_b128 v[144:147], v89 offset:53248
  v_mfma_f32_32x32x16_bf16 v[96:111], v[184:187], v[176:179], v[96:111]
  ds_read_b64_tr_b16 v[148:149], v93 offset:4096
  ds_read_b64_tr_b16 v[150:151], v93 offset:4608
  v_mfma_f32_32x32x16_bf16 v[112:127], v[184:187], v[180:183], v[112:127]
  ds_read_b128 v[152:155], v90 offset:49152
  ds_read_b128 v[156:159], v90 offset:53248
  v_mfma_f32_16x16x32_bf16 v[200:203], v[204:207], v[196:199], v[200:203]
  ds_read_b64_tr_b16 v[160:161], v93 offset:8192
  ds_read_b64_tr_b16 v[162:163], v93 offset:8704
  v_mfma_f32_32x32x16_bf16 v[96:111], v[196:199], v[188:191], v[96:111]
  ds_read_b128 v[164:167], v91 offset:49152
  ds_read_b128 v[168:171], v91 offset:53248
  v_mfma_f32_32x32x16_bf16 v[112:127], v[196:199], v[192:195], v[112:127]
  ds_read_b64_tr_b16 v[172:173], v93 offset:12288
  ds_read_b64_tr_b16 v[174:175], v93 offset:12800
  s_waitcnt lgkmcnt(12)
  v_mfma_f32_16x16x32_bf16 v[200:203], v[204:207], v[136:139], v[200:203]
  v_mfma_f32_32x32x16_bf16 v[96:111], v[136:139], v[128:131], v[96:111]
  v_mfma_f32_32x32x16_bf16 v[112:127], v[136:139], v[132:135], v[112:127]
  s_waitcnt lgkmcnt(8)
  v_mfma_f32_16x16x32_bf16 v[200:203], v[204:207], v[148:151], v[200:203]
  v_mfma_f32_32x32x16_bf16 v[96:111], v[148:151], v[140:143], v[96:111]
  v_mfma_f32_32x32x16_bf16 v[112:127], v[148:151], v[144:147], v[112:127]
  s_waitcnt lgkmcnt(0)
  s_barrier
  ds_read_b128 v[176:179], v88 offset:57344
  ds_read_b128 v[180:183], v88 offset:61440
  ds_read_b64_tr_b16 v[184:185], v93 offset:16384
  ds_read_b64_tr_b16 v[186:187], v93 offset:16896
  v_mfma_f32_16x16x32_bf16 v[200:203], v[204:207], v[160:163], v[200:203]
  ds_read_b128 v[188:191], v89 offset:57344
  ds_read_b128 v[192:195], v89 offset:61440
  v_mfma_f32_32x32x16_bf16 v[96:111], v[160:163], v[152:155], v[96:111]
  ds_read_b64_tr_b16 v[196:197], v93 offset:20480
  ds_read_b64_tr_b16 v[198:199], v93 offset:20992
  v_mfma_f32_32x32x16_bf16 v[112:127], v[160:163], v[156:159], v[112:127]
  ds_read_b128 v[128:131], v90 offset:57344
  ds_read_b128 v[132:135], v90 offset:61440
  v_mfma_f32_16x16x32_bf16 v[200:203], v[204:207], v[172:175], v[200:203]
  ds_read_b64_tr_b16 v[136:137], v93 offset:24576
  ds_read_b64_tr_b16 v[138:139], v93 offset:25088
  v_mfma_f32_32x32x16_bf16 v[96:111], v[172:175], v[164:167], v[96:111]
  ds_read_b128 v[140:143], v91 offset:57344
  ds_read_b128 v[144:147], v91 offset:61440
  v_mfma_f32_32x32x16_bf16 v[112:127], v[172:175], v[168:171], v[112:127]
  ds_read_b64_tr_b16 v[148:149], v93 offset:28672
  ds_read_b64_tr_b16 v[150:151], v93 offset:29184
  s_waitcnt lgkmcnt(12)
  v_mfma_f32_16x16x32_bf16 v[200:203], v[204:207], v[184:187], v[200:203]
  buffer_load_dwordx4 v[68:71], v83, s[48:51], s35 offen sc1
  v_mfma_f32_32x32x16_bf16 v[96:111], v[184:187], v[176:179], v[96:111]
  v_mfma_f32_32x32x16_bf16 v[112:127], v[184:187], v[180:183], v[112:127]
  s_waitcnt lgkmcnt(8)
  v_mfma_f32_16x16x32_bf16 v[200:203], v[204:207], v[196:199], v[200:203]
  v_mfma_f32_32x32x16_bf16 v[96:111], v[196:199], v[188:191], v[96:111]
  v_mfma_f32_32x32x16_bf16 v[112:127], v[196:199], v[192:195], v[112:127]
  ds_read_b64 v[224:225], v64
  ds_read_b64 v[226:227], v64 offset:256
  s_waitcnt lgkmcnt(0)
  v_mfma_f32_16x16x32_bf16 v[200:203], v[204:207], v[136:139], v[200:203]
  v_mfma_f32_16x16x32_bf16 v[200:203], v[204:207], v[148:151], v[200:203]
  v_mfma_f32_32x32x16_bf16 v[96:111], v[136:139], v[128:131], v[96:111]
  v_cvt_pk_bf16_f32 v40, -v224, -v224
  v_cvt_pk_bf16_f32 v41, -v224, 0
  v_mov_b32 v42, 0
  v_mov_b32 v43, 0
  v_mfma_f32_32x32x16_bf16 v[112:127], v[136:139], v[132:135], v[112:127]
  v_cvt_pk_bf16_f32 v44, -v226, -v226
  v_cvt_pk_bf16_f32 v45, -v226, 0
  v_mov_b32 v46, 0
  v_mov_b32 v47, 0
  v_mfma_f32_32x32x16_bf16 v[96:111], v[148:151], v[140:143], v[96:111]
  s_mov_b32 s20, 0xffff0000
  s_mov_b32 s21, 0xffff0000
  v_cndmask_b32_e64 v2, v200, v201, s[20:21]
  v_mul_f32 v2, 0.5, v2
  v_cvt_pk_bf16_f32 v3, v2, v2
  v_and_b32 v3, 0xffff0000, v3
  v_mfma_f32_32x32x16_bf16 v[112:127], v[148:151], v[144:147], v[112:127]
  v_sub_f32 v2, v2, v3
  v_cvt_pk_bf16_f32 v4, v2, v2
  v_and_b32 v4, 0xffff0000, v4
  v_sub_f32 v2, v2, v4
  v_cvt_pk_bf16_f32 v56, v3, v4
  v_cvt_pk_bf16_f32 v57, v2, 0
  s_nop 1
  v_mfma_f32_32x32x16_bf16 v[96:111], v[56:59], v[40:43], v[96:111]
  v_mfma_f32_32x32x16_bf16 v[112:127], v[56:59], v[44:47], v[112:127]
  s_nop 10
  v_mul_f32 v96, v96, v225
  v_mul_f32 v97, v97, v225
  v_mul_f32 v98, v98, v225
  v_mul_f32 v99, v99, v225
  v_mul_f32 v100, v100, v225
  v_mul_f32 v101, v101, v225
  v_mul_f32 v102, v102, v225
  v_mul_f32 v103, v103, v225
  v_cvt_pk_bf16_f32 v128, v96, v97
  v_cvt_pk_bf16_f32 v129, v98, v99
  v_cvt_pk_bf16_f32 v130, v100, v101
  v_cvt_pk_bf16_f32 v131, v102, v103
  buffer_store_dwordx4 v[128:131], v81, s[48:51], s33 offen offset:0 sc1
  v_add3_u32 v144, v128, v129, v130
  v_add3_u32 v144, v144, v131, s7
  v_mul_f32 v104, v104, v225
  v_mul_f32 v105, v105, v225
  v_mul_f32 v106, v106, v225
  v_mul_f32 v107, v107, v225
  v_mul_f32 v108, v108, v225
  v_mul_f32 v109, v109, v225
  v_mul_f32 v110, v110, v225
  v_mul_f32 v111, v111, v225
  v_cvt_pk_bf16_f32 v132, v104, v105
  v_cvt_pk_bf16_f32 v133, v106, v107
  v_cvt_pk_bf16_f32 v134, v108, v109
  v_cvt_pk_bf16_f32 v135, v110, v111
  buffer_store_dwordx4 v[132:135], v81, s[48:51], s33 offen offset:1024 sc1
  v_add3_u32 v146, v132, v133, v134
  v_add3_u32 v146, v146, v135, s7
  v_mul_f32 v112, v112, v227
  v_mul_f32 v113, v113, v227
  v_mul_f32 v114, v114, v227
  v_mul_f32 v115, v115, v227
  v_mul_f32 v116, v116, v227
  v_mul_f32 v117, v117, v227
  v_mul_f32 v118, v118, v227
  v_mul_f32 v119, v119, v227
  v_cvt_pk_bf16_f32 v136, v112, v113
  v_cvt_pk_bf16_f32 v137, v114, v115
  v_cvt_pk_bf16_f32 v138, v116, v117
  v_cvt_pk_bf16_f32 v139, v118, v119
  buffer_store_dwordx4 v[136:139], v81, s[48:51], s36 offen offset:0 sc1
  v_add3_u32 v145, v136, v137, v138
  v_add3_u32 v145, v145, v139, s7
  v_mul_f32 v120, v120, v227
  v_mul_f32 v121, v121, v227
  v_mul_f32 v122, v122, v227
  v_mul_f32 v123, v123, v227
  v_mul_f32 v124, v124, v227
  v_mul_f32 v125, v125, v227
  v_mul_f32 v126, v126, v227
  v_mul_f32 v127, v127, v227
  v_cvt_pk_bf16_f32 v140, v120, v121
  v_cvt_pk_bf16_f32 v141, v122, v123
  v_cvt_pk_bf16_f32 v142, v124, v125
  v_cvt_pk_bf16_f32 v143, v126, v127
  buffer_store_dwordx4 v[140:143], v81, s[48:51], s36 offen offset:1024 sc1
  v_add3_u32 v147, v140, v141, v142
  v_add3_u32 v147, v147, v143, s7
  buffer_store_dwordx2 v[144:145], v82, s[48:51], s34 offen offset:0 sc1
  buffer_store_dwordx2 v[146:147], v82, s[48:51], s34 offen offset:512 sc1
  s_mov_b32 s39, 1024
  s_branch L_cpost
L_vwave:
  s_barrier
  ds_read_b128 v[128:131], v88 offset:0
  ds_read_b128 v[132:135], v88 offset:4096
  ds_read_b64_tr_b16 v[136:137], v92 offset:32768
  ds_read_b64_tr_b16 v[138:139], v92 offset:33280
  ds_read_b128 v[140:143], v89 offset:0
  ds_read_b128 v[144:147], v89 offset:4096
  ds_read_b64_tr_b16 v[148:149], v92 offset:36864
  ds_read_b64_tr_b16 v[150:151], v92 offset:37376
  ds_read_b128 v[152:155], v90 offset:0
  ds_read_b128 v[156:159], v90 offset:4096
  ds_read_b64_tr_b16 v[160:161], v92 offset:40960
  ds_read_b64_tr_b16 v[162:163], v92 offset:41472
  ds_read_b128 v[164:167], v91 offset:0
  ds_read_b128 v[168:171], v91 offset:4096
  ds_read_b64_tr_b16 v[172:173], v92 offset:45056
  ds_read_b64_tr_b16 v[174:175], v92 offset:45568
  s_waitcnt lgkmcnt(12)
  v_mfma_f32_16x16x32_bf16 v[200:203], v[204:207], v[136:139], v[200:203]
  v_mfma_f32_32x32x16_bf16 v[96:111], v[128:131], v[136:139], 0
  v_mfma_f32_32x32x16_bf16 v[112:127], v[132:135], v[136:139], 0
  s_waitcnt lgkmcnt(8)
  v_mfma_f32_16x16x32_bf16 v[200:203], v[204:207], v[148:151], v[200:203]
  v_mfma_f32_32x32x16_bf16 v[96:111], v[140:143], v[148:151], v[96:111]
  v_mfma_f32_32x32x16_bf16 v[112:127], v[144:147], v[148:151], v[112:127]
  s_waitcnt lgkmcnt(0)
  s_barrier
  ds_read_b128 v[176:179], v88 offset:8192
  ds_read_b128 v[180:183], v88 offset:12288
  ds_read_b64_tr_b16 v[184:185], v93 offset:0
  ds_read_b64_tr_b16 v[186:187], v93 offset:512
  v_mfma_f32_16x16x32_bf16 v[200:203], v[204:207], v[160:163], v[200:203]
  ds_read_b128 v[188:191], v89 offset:8192
  ds_read_b128 v[192:195], v89 offset:12288
  v_mfma_f32_32x32x16_bf16 v[96:111], v[152:155], v[160:163], v[96:111]
  ds_read_b64_tr_b16 v[196:197], v93 offset:4096
  ds_read_b64_tr_b16 v[198:199], v93 offset:4608
  v_mfma_f32_32x32x16_bf16 v[112:127], v[156:159], v[160:163], v[112:127]
  ds_read_b128 v[128:131], v90 offset:8192
  ds_read_b128 v[132:135], v90 offset:12288
  v_mfma_f32_16x16x32_bf16 v[200:203], v[204:207], v[172:175], v[200:203]
  ds_read_b64_tr_b16 v[136:137], v93 offset:8192
  ds_read_b64_tr_b16 v[138:139], v93 offset:8704
  v_mfma_f32_32x32x16_bf16 v[96:111], v[164:167], v[172:175], v[96:111]
  ds_read_b128 v[140:143], v91 offset:8192
  ds_read_b128 v[144:147], v91 offset:12288
  v_mfma_f32_32x32x16_bf16 v[112:127], v[168:171], v[172:175], v[112:127]
  ds_read_b64_tr_b16 v[148:149], v93 offset:12288
  ds_read_b64_tr_b16 v[150:151], v93 offset:12800
  s_waitcnt lgkmcnt(12)
  v_mfma_f32_16x16x32_bf16 v[200:203], v[204:207], v[184:187], v[200:203]
  s_sub_u32 s20, 3, s15
  s_cmp_eq_u32 s15, 0
  s_cselect_b32 s21, 4, 1
  s_sub_u32 s22, s3, s20
  s_lshl_b32 s22, s22, 3
  v_mfma_f32_32x32x16_bf16 v[96:111], v[176:179], v[184:187], v[96:111]
  s_add_u32 s22, s22, s4
  s_cmp_ge_u32 s3, s20
  s_cselect_b32 s16, -1, 0
  s_cselect_b32 s22, s22, 0x10000
  s_sub_u32 s23, s3, s21
  v_mfma_f32_32x32x16_bf16 v[112:127], v[180:183], v[184:187], v[112:127]
  s_lshl_b32 s23, s23, 3
  s_add_u32 s23, s23, s4
  s_cmp_ge_u32 s3, s21
  s_cselect_b32 s17, -1, 0
  s_cselect_b32 s23, s23, 0x10000
  s_waitcnt lgkmcnt(8)
  v_mfma_f32_16x16x32_bf16 v[200:203], v[204:207], v[196:199], v[200:203]
  s_lshl_b32 s90, s22, 14
  s_add_u32 s90, s90, 1048576
  s_add_u32 s91, s90, 4096
  s_lshl_b32 s92, s23, 14
  s_add_u32 s92, s92, 1048576
  v_mfma_f32_32x32x16_bf16 v[96:111], v[188:191], v[196:199], v[96:111]
  s_add_u32 s93, s92, 4096
  s_lshl_b32 s94, s22, 12
  s_add_u32 s94, s94, 5242880
  s_lshl_b32 s95, s23, 12
  s_add_u32 s95, s95, 5242880
  v_mfma_f32_32x32x16_bf16 v[112:127], v[192:195], v[196:199], v[112:127]
  s_waitcnt lgkmcnt(0)
  s_barrier
  ds_read_b128 v[152:155], v88 offset:16384
  ds_read_b128 v[156:159], v88 offset:20480
  ds_read_b64_tr_b16 v[160:161], v93 offset:16384
  ds_read_b64_tr_b16 v[162:163], v93 offset:16896
  v_mfma_f32_16x16x32_bf16 v[200:203], v[204:207], v[136:139], v[200:203]
  ds_read_b128 v[164:167], v89 offset:16384
  ds_read_b128 v[168:171], v89 offset:20480
  v_mfma_f32_32x32x16_bf16 v[96:111], v[128:131], v[136:139], v[96:111]
  ds_read_b64_tr_b16 v[172:173], v93 offset:20480
  ds_read_b64_tr_b16 v[174:175], v93 offset:20992
  v_mfma_f32_32x32x16_bf16 v[112:127], v[132:135], v[136:139], v[112:127]
  ds_read_b128 v[176:179], v90 offset:16384
  ds_read_b128 v[180:183], v90 offset:20480
  v_mfma_f32_16x16x32_bf16 v[200:203], v[204:207], v[148:151], v[200:203]
  ds_read_b64_tr_b16 v[184:185], v93 offset:24576
  ds_read_b64_tr_b16 v[186:187], v93 offset:25088
  v_mfma_f32_32x32x16_bf16 v[96:111], v[140:143], v[148:151], v[96:111]
  ds_read_b128 v[188:191], v91 offset:16384
  ds_read_b128 v[192:195], v91 offset:20480
  v_mfma_f32_32x32x16_bf16 v[112:127], v[144:147], v[148:151], v[112:127]
  ds_read_b64_tr_b16 v[196:197], v93 offset:28672
  ds_read_b64_tr_b16 v[198:199], v93 offset:29184
  s_waitcnt lgkmcnt(12)
  v_mfma_f32_16x16x32_bf16 v[200:203], v[204:207], v[160:163], v[200:203]
  s_lshl_b32 s82, s5, 16
  s_and_b32 s20, s4, 3
  s_lshl_b32 s20, s20, 8
  s_add_u32 s82, s82, s20
  v_mfma_f32_32x32x16_bf16 v[96:111], v[152:155], v[160:163], v[96:111]
  s_xor_b32 s83, s5, 4
  s_lshl_b32 s83, s83, 14
  s_mov_b32 s13, s3
  s_add_u32 s84, s3, 4
  v_mfma_f32_32x32x16_bf16 v[112:127], v[156:159], v[160:163], v[112:127]
  s_lshl_b32 s81, s3, 1
  s_lshr_b32 s21, s4, 2
  s_add_u32 s81, s81, s21
  s_lshl_b32 s80, s81, 15
  s_waitcnt lgkmcnt(8)
  v_mfma_f32_16x16x32_bf16 v[200:203], v[204:207], v[172:175], v[200:203]
  s_add_u32 s80, s80, s20
  s_lshl_b32 s20, s14, 6
  s_add_u32 s80, s80, s20
  s_mov_b32 s78, 1409024
  v_mfma_f32_32x32x16_bf16 v[96:111], v[164:167], v[172:175], v[96:111]
  s_mov_b32 s79, 0x20000
  s_mov_b32 s66, 2097152
  s_mov_b32 s67, 0x20000
  s_mov_b32 s62, 524288
  v_mfma_f32_32x32x16_bf16 v[112:127], v[168:171], v[172:175], v[112:127]
  s_mov_b32 s63, 0x20000
  s_mov_b32 s50, 16777216
  s_mov_b32 s51, 0x20000
  s_waitcnt lgkmcnt(0)
  s_barrier
  ds_read_b128 v[128:131], v88 offset:24576
  ds_read_b128 v[132:135], v88 offset:28672
  ds_read_b64_tr_b16 v[136:137], v92 offset:0
  ds_read_b64_tr_b16 v[138:139], v92 offset:512
  v_mfma_f32_16x16x32_bf16 v[200:203], v[204:207], v[184:187], v[200:203]
  ds_read_b128 v[140:143], v89 offset:24576
  ds_read_b128 v[144:147], v89 offset:28672
  v_mfma_f32_32x32x16_bf16 v[96:111], v[176:179], v[184:187], v[96:111]
  ds_read_b64_tr_b16 v[148:149], v92 offset:4096
  ds_read_b64_tr_b16 v[150:151], v92 offset:4608
  v_mfma_f32_32x32x16_bf16 v[112:127], v[180:183], v[184:187], v[112:127]
  ds_read_b128 v[152:155], v90 offset:24576
  ds_read_b128 v[156:159], v90 offset:28672
  v_mfma_f32_16x16x32_bf16 v[200:203], v[204:207], v[196:199], v[200:203]
  ds_read_b64_tr_b16 v[160:161], v92 offset:8192
  ds_read_b64_tr_b16 v[162:163], v92 offset:8704
  v_mfma_f32_32x32x16_bf16 v[96:111], v[188:191], v[196:199], v[96:111]
  ds_read_b128 v[164:167], v91 offset:24576
  ds_read_b128 v[168:171], v91 offset:28672
  v_mfma_f32_32x32x16_bf16 v[112:127], v[192:195], v[196:199], v[112:127]
  ds_read_b64_tr_b16 v[172:173], v92 offset:12288
  ds_read_b64_tr_b16 v[174:175], v92 offset:12800
  s_waitcnt lgkmcnt(12)
  v_mfma_f32_16x16x32_bf16 v[200:203], v[204:207], v[136:139], v[200:203]
  v_mov_b32 v58, 0
  v_mov_b32 v59, 0
  v_lshrrev_b32 v64, 1, v80
  v_mfma_f32_32x32x16_bf16 v[96:111], v[128:131], v[136:139], v[96:111]
  v_add_u32 v64, 155904, v64
  v_mov_b32 v66, 155776
  v_and_b32 v2, 0x2f, v1
  v_mfma_f32_32x32x16_bf16 v[112:127], v[132:135], v[136:139], v[112:127]
  v_bfe_u32 v3, v1, 4, 1
  s_lshl_b32 s20, s12, 1
  v_add_u32 v3, s20, v3
  s_waitcnt lgkmcnt(8)
  v_mfma_f32_16x16x32_bf16 v[200:203], v[204:207], v[148:151], v[200:203]
  v_lshlrev_b32 v81, 4, v2
  v_lshl_add_u32 v81, v3, 10, v81
  v_lshrrev_b32 v82, 1, v81
  v_mfma_f32_32x32x16_bf16 v[96:111], v[140:143], v[148:151], v[96:111]
  v_add_u32 v81, 8192, v81
  v_lshrrev_b32 v65, 5, v1
  v_lshlrev_b32 v65, 4, v65
  v_mfma_f32_32x32x16_bf16 v[112:127], v[144:147], v[148:151], v[112:127]
  v_add_u32 v65, 156416, v65
  s_waitcnt lgkmcnt(0)
  s_barrier
  ds_read_b128 v[176:179], v88 offset:32768
  ds_read_b128 v[180:183], v88 offset:36864
  ds_read_b64_tr_b16 v[184:185], v92 offset:16384
  ds_read_b64_tr_b16 v[186:187], v92 offset:16896
  v_mfma_f32_16x16x32_bf16 v[200:203], v[204:207], v[160:163], v[200:203]
  ds_read_b128 v[188:191], v89 offset:32768
  ds_read_b128 v[192:195], v89 offset:36864
  v_mfma_f32_32x32x16_bf16 v[96:111], v[152:155], v[160:163], v[96:111]
  ds_read_b64_tr_b16 v[196:197], v92 offset:20480
  ds_read_b64_tr_b16 v[198:199], v92 offset:20992
  v_mfma_f32_32x32x16_bf16 v[112:127], v[156:159], v[160:163], v[112:127]
  ds_read_b128 v[128:131], v90 offset:32768
  ds_read_b128 v[132:135], v90 offset:36864
  v_mfma_f32_16x16x32_bf16 v[200:203], v[204:207], v[172:175], v[200:203]
  ds_read_b64_tr_b16 v[136:137], v92 offset:24576
  ds_read_b64_tr_b16 v[138:139], v92 offset:25088
  v_mfma_f32_32x32x16_bf16 v[96:111], v[164:167], v[172:175], v[96:111]
  ds_read_b128 v[140:143], v91 offset:32768
  ds_read_b128 v[144:147], v91 offset:36864
  v_mfma_f32_32x32x16_bf16 v[112:127], v[168:171], v[172:175], v[112:127]
  ds_read_b64_tr_b16 v[148:149], v92 offset:28672
  ds_read_b64_tr_b16 v[150:151], v92 offset:29184
  s_waitcnt lgkmcnt(12)
  v_mfma_f32_16x16x32_bf16 v[200:203], v[204:207], v[184:187], v[200:203]
  s_lshl_b32 s20, s14, 10
  v_lshlrev_b32 v242, 4, v1
  s_lshl_b32 s21, s5, 12
  s_add_u32 s21, s21, 131072
  v_add_u32 v246, s21, v242
  v_mfma_f32_32x32x16_bf16 v[96:111], v[176:179], v[184:187], v[96:111]
  v_add_u32 v242, s20, v242
  v_lshrrev_b32 v244, 1, v242
  v_add_u32 v243, 8192, v242
  v_lshrrev_b32 v2, 4, v1
  v_and_b32 v3, 15, v1
  v_mfma_f32_32x32x16_bf16 v[112:127], v[180:183], v[184:187], v[112:127]
  v_lshlrev_b32 v4, 2, v2
  v_xor_b32 v3, v3, v4
  v_lshlrev_b32 v3, 4, v3
  v_lshl_add_u32 v250, v2, 10, v3
  v_add_u32 v251, 3072, v250
  s_waitcnt lgkmcnt(8)
  v_mfma_f32_16x16x32_bf16 v[200:203], v[204:207], v[196:199], v[200:203]
  v_add_u32 v252, 6144, v250
  v_add_u32 v253, 9216, v250
  v_and_b32 v3, 31, v1
  v_lshrrev_b32 v4, 5, v1
  v_lshlrev_b32 v247, 10, v3
  v_mfma_f32_32x32x16_bf16 v[96:111], v[188:191], v[196:199], v[96:111]
  v_lshl_add_u32 v247, v4, 4, v247
  v_mul_u32_u24 v4, 22528, v4
  v_lshl_add_u32 v255, v3, 4, v4
  v_mov_b32 v240, 0
  v_mov_b32 v241, 0
  v_mfma_f32_32x32x16_bf16 v[112:127], v[192:195], v[196:199], v[112:127]
  s_waitcnt lgkmcnt(0)
  s_barrier
  ds_read_b128 v[152:155], v88 offset:40960
  ds_read_b128 v[156:159], v88 offset:45056
  ds_read_b64_tr_b16 v[160:161], v92 offset:32768
  ds_read_b64_tr_b16 v[162:163], v92 offset:33280
  v_mfma_f32_16x16x32_bf16 v[200:203], v[204:207], v[136:139], v[200:203]
  ds_read_b128 v[164:167], v89 offset:40960
  ds_read_b128 v[168:171], v89 offset:45056
  v_mfma_f32_32x32x16_bf16 v[96:111], v[128:131], v[136:139], v[96:111]
  ds_read_b64_tr_b16 v[172:173], v92 offset:36864
  ds_read_b64_tr_b16 v[174:175], v92 offset:37376
  v_mfma_f32_32x32x16_bf16 v[112:127], v[132:135], v[136:139], v[112:127]
  ds_read_b128 v[176:179], v90 offset:40960
  ds_read_b128 v[180:183], v90 offset:45056
  v_mfma_f32_16x16x32_bf16 v[200:203], v[204:207], v[148:151], v[200:203]
  ds_read_b64_tr_b16 v[184:185], v92 offset:40960
  ds_read_b64_tr_b16 v[186:187], v92 offset:41472
  v_mfma_f32_32x32x16_bf16 v[96:111], v[140:143], v[148:151], v[96:111]
  ds_read_b128 v[188:191], v91 offset:40960
  ds_read_b128 v[192:195], v91 offset:45056
  v_mfma_f32_32x32x16_bf16 v[112:127], v[144:147], v[148:151], v[112:127]
  ds_read_b64_tr_b16 v[196:197], v92 offset:45056
  ds_read_b64_tr_b16 v[198:199], v92 offset:45568
  s_waitcnt lgkmcnt(12)
  v_mfma_f32_16x16x32_bf16 v[200:203], v[204:207], v[160:163], v[200:203]
  v_mfma_f32_32x32x16_bf16 v[96:111], v[152:155], v[160:163], v[96:111]
  v_mfma_f32_32x32x16_bf16 v[112:127], v[156:159], v[160:163], v[112:127]
  s_waitcnt lgkmcnt(8)
  v_mfma_f32_16x16x32_bf16 v[200:203], v[204:207], v[172:175], v[200:203]
  v_mfma_f32_32x32x16_bf16 v[96:111], v[164:167], v[172:175], v[96:111]
  v_mfma_f32_32x32x16_bf16 v[112:127], v[168:171], v[172:175], v[112:127]
  s_waitcnt lgkmcnt(0)
  s_barrier
  ds_read_b128 v[128:131], v88 offset:49152
  ds_read_b128 v[132:135], v88 offset:53248
  ds_read_b64_tr_b16 v[136:137], v93 offset:0
  ds_read_b64_tr_b16 v[138:139], v93 offset:512
  v_mfma_f32_16x16x32_bf16 v[200:203], v[204:207], v[184:187], v[200:203]
  ds_read_b128 v[140:143], v89 offset:49152
  ds_read_b128 v[144:147], v89 offset:53248
  v_mfma_f32_32x32x16_bf16 v[96:111], v[176:179], v[184:187], v[96:111]
  ds_read_b64_tr_b16 v[148:149], v93 offset:4096
  ds_read_b64_tr_b16 v[150:151], v93 offset:4608
  v_mfma_f32_32x32x16_bf16 v[112:127], v[180:183], v[184:187], v[112:127]
  ds_read_b128 v[152:155], v90 offset:49152
  ds_read_b128 v[156:159], v90 offset:53248
  v_mfma_f32_16x16x32_bf16 v[200:203], v[204:207], v[196:199], v[200:203]
  ds_read_b64_tr_b16 v[160:161], v93 offset:8192
  ds_read_b64_tr_b16 v[162:163], v93 offset:8704
  v_mfma_f32_32x32x16_bf16 v[96:111], v[188:191], v[196:199], v[96:111]
  ds_read_b128 v[164:167], v91 offset:49152
  ds_read_b128 v[168:171], v91 offset:53248
  v_mfma_f32_32x32x16_bf16 v[112:127], v[192:195], v[196:199], v[112:127]
  ds_read_b64_tr_b16 v[172:173], v93 offset:12288
  ds_read_b64_tr_b16 v[174:175], v93 offset:12800
  s_waitcnt lgkmcnt(12)
  v_mfma_f32_16x16x32_bf16 v[200:203], v[204:207], v[136:139], v[200:203]
  v_mfma_f32_32x32x16_bf16 v[96:111], v[128:131], v[136:139], v[96:111]
  v_mfma_f32_32x32x16_bf16 v[112:127], v[132:135], v[136:139], v[112:127]
  s_waitcnt lgkmcnt(8)
  v_mfma_f32_16x16x32_bf16 v[200:203], v[204:207], v[148:151], v[200:203]
  v_mfma_f32_32x32x16_bf16 v[96:111], v[140:143], v[148:151], v[96:111]
  v_mfma_f32_32x32x16_bf16 v[112:127], v[144:147], v[148:151], v[112:127]
  s_waitcnt lgkmcnt(0)
  s_barrier
  ds_read_b128 v[176:179], v88 offset:57344
  ds_read_b128 v[180:183], v88 offset:61440
  ds_read_b64_tr_b16 v[184:185], v93 offset:16384
  ds_read_b64_tr_b16 v[186:187], v93 offset:16896
  v_mfma_f32_16x16x32_bf16 v[200:203], v[204:207], v[160:163], v[200:203]
  ds_read_b128 v[188:191], v89 offset:57344
  ds_read_b128 v[192:195], v89 offset:61440
  v_mfma_f32_32x32x16_bf16 v[96:111], v[152:155], v[160:163], v[96:111]
  ds_read_b64_tr_b16 v[196:197], v93 offset:20480
  ds_read_b64_tr_b16 v[198:199], v93 offset:20992
  v_mfma_f32_32x32x16_bf16 v[112:127], v[156:159], v[160:163], v[112:127]
  ds_read_b128 v[128:131], v90 offset:57344
  ds_read_b128 v[132:135], v90 offset:61440
  v_mfma_f32_16x16x32_bf16 v[200:203], v[204:207], v[172:175], v[200:203]
  ds_read_b64_tr_b16 v[136:137], v93 offset:24576
  ds_read_b64_tr_b16 v[138:139], v93 offset:25088
  v_mfma_f32_32x32x16_bf16 v[96:111], v[164:167], v[172:175], v[96:111]
  ds_read_b128 v[140:143], v91 offset:57344
  ds_read_b128 v[144:147], v91 offset:61440
  v_mfma_f32_32x32x16_bf16 v[112:127], v[168:171], v[172:175], v[112:127]
  ds_read_b64_tr_b16 v[148:149], v93 offset:28672
  ds_read_b64_tr_b16 v[150:151], v93 offset:29184
  s_waitcnt lgkmcnt(12)
  v_mfma_f32_16x16x32_bf16 v[200:203], v[204:207], v[184:187], v[200:203]
  buffer_load_dwordx4 v[68:71], v83, s[48:51], s35 offen sc1
  v_mfma_f32_32x32x16_bf16 v[96:111], v[176:179], v[184:187], v[96:111]
  v_mfma_f32_32x32x16_bf16 v[112:127], v[180:183], v[184:187], v[112:127]
  s_waitcnt lgkmcnt(8)
  v_mfma_f32_16x16x32_bf16 v[200:203], v[204:207], v[196:199], v[200:203]
  v_mfma_f32_32x32x16_bf16 v[96:111], v[188:191], v[196:199], v[96:111]
  v_mfma_f32_32x32x16_bf16 v[112:127], v[192:195], v[196:199], v[112:127]
  ds_read_b64 v[224:225], v64
  ds_read_b64 v[226:227], v64 offset:256
  ds_read_b128 v[8:11], v65 offset:0
  ds_read_b128 v[12:15], v65 offset:32
  ds_read_b128 v[16:19], v65 offset:64
  ds_read_b128 v[20:23], v65 offset:96
  ds_read_b128 v[24:27], v65 offset:128
  ds_read_b128 v[28:31], v65 offset:160
  ds_read_b128 v[32:35], v65 offset:192
  ds_read_b128 v[36:39], v65 offset:224
  s_waitcnt lgkmcnt(0)
  v_mfma_f32_16x16x32_bf16 v[200:203], v[204:207], v[136:139], v[200:203]
  v_mfma_f32_16x16x32_bf16 v[200:203], v[204:207], v[148:151], v[200:203]
  v_mfma_f32_32x32x16_bf16 v[96:111], v[128:131], v[136:139], v[96:111]
  v_cvt_pk_bf16_f32 v40, -v224, -v224
  v_cvt_pk_bf16_f32 v41, -v224, 0
  v_mov_b32 v42, 0
  v_mov_b32 v43, 0
  v_mfma_f32_32x32x16_bf16 v[112:127], v[132:135], v[136:139], v[112:127]
  v_cvt_pk_bf16_f32 v44, -v226, -v226
  v_cvt_pk_bf16_f32 v45, -v226, 0
  v_mov_b32 v46, 0
  v_mov_b32 v47, 0
  v_mfma_f32_32x32x16_bf16 v[96:111], v[140:143], v[148:151], v[96:111]
  s_mov_b32 s20, 0xffff0000
  s_mov_b32 s21, 0xffff0000
  v_cndmask_b32_e64 v2, v200, v201, s[20:21]
  v_mul_f32 v2, 0.5, v2
  v_cvt_pk_bf16_f32 v3, v2, v2
  v_and_b32 v3, 0xffff0000, v3
  v_mfma_f32_32x32x16_bf16 v[112:127], v[144:147], v[148:151], v[112:127]
  v_sub_f32 v2, v2, v3
  v_cvt_pk_bf16_f32 v4, v2, v2
  v_and_b32 v4, 0xffff0000, v4
  v_sub_f32 v2, v2, v4
  v_cvt_pk_bf16_f32 v56, v3, v4
  v_cvt_pk_bf16_f32 v57, v2, 0
  s_nop 1
  v_mfma_f32_32x32x16_bf16 v[96:111], v[40:43], v[56:59], v[96:111]
  v_mfma_f32_32x32x16_bf16 v[112:127], v[44:47], v[56:59], v[112:127]
  s_nop 10
  v_mul_f32 v96, v96, v8
  v_mul_f32 v97, v97, v9
  v_mul_f32 v98, v98, v10
  v_mul_f32 v99, v99, v11
  v_mul_f32 v100, v100, v12
  v_mul_f32 v101, v101, v13
  v_mul_f32 v102, v102, v14
  v_mul_f32 v103, v103, v15
  v_cvt_pk_bf16_f32 v128, v96, v97
  v_cvt_pk_bf16_f32 v129, v98, v99
  v_cvt_pk_bf16_f32 v130, v100, v101
  v_cvt_pk_bf16_f32 v131, v102, v103
  buffer_store_dwordx4 v[128:131], v81, s[48:51], s33 offen offset:0 sc1
  v_add3_u32 v144, v128, v129, v130
  v_add3_u32 v144, v144, v131, s7
  v_mul_f32 v104, v104, v16
  v_mul_f32 v105, v105, v17
  v_mul_f32 v106, v106, v18
  v_mul_f32 v107, v107, v19
  v_mul_f32 v108, v108, v20
  v_mul_f32 v109, v109, v21
  v_mul_f32 v110, v110, v22
  v_mul_f32 v111, v111, v23
  v_cvt_pk_bf16_f32 v132, v104, v105
  v_cvt_pk_bf16_f32 v133, v106, v107
  v_cvt_pk_bf16_f32 v134, v108, v109
  v_cvt_pk_bf16_f32 v135, v110, v111
  buffer_store_dwordx4 v[132:135], v81, s[48:51], s33 offen offset:256 sc1
  v_add3_u32 v146, v132, v133, v134
  v_add3_u32 v146, v146, v135, s7
  v_mul_f32 v112, v112, v24
  v_mul_f32 v113, v113, v25
  v_mul_f32 v114, v114, v26
  v_mul_f32 v115, v115, v27
  v_mul_f32 v116, v116, v28
  v_mul_f32 v117, v117, v29
  v_mul_f32 v118, v118, v30
  v_mul_f32 v119, v119, v31
  v_cvt_pk_bf16_f32 v136, v112, v113
  v_cvt_pk_bf16_f32 v137, v114, v115
  v_cvt_pk_bf16_f32 v138, v116, v117
  v_cvt_pk_bf16_f32 v139, v118, v119
  buffer_store_dwordx4 v[136:139], v81, s[48:51], s36 offen offset:0 sc1
  v_add3_u32 v145, v136, v137, v138
  v_add3_u32 v145, v145, v139, s7
  v_mul_f32 v120, v120, v32
  v_mul_f32 v121, v121, v33
  v_mul_f32 v122, v122, v34
  v_mul_f32 v123, v123, v35
  v_mul_f32 v124, v124, v36
  v_mul_f32 v125, v125, v37
  v_mul_f32 v126, v126, v38
  v_mul_f32 v127, v127, v39
  v_cvt_pk_bf16_f32 v140, v120, v121
  v_cvt_pk_bf16_f32 v141, v122, v123
  v_cvt_pk_bf16_f32 v142, v124, v125
  v_cvt_pk_bf16_f32 v143, v126, v127
  buffer_store_dwordx4 v[140:143], v81, s[48:51], s36 offen offset:256 sc1
  v_add3_u32 v147, v140, v141, v142
  v_add3_u32 v147, v147, v143, s7
  buffer_store_dwordx2 v[144:145], v82, s[48:51], s34 offen offset:2048 sc1
  buffer_store_dwordx2 v[146:147], v82, s[48:51], s34 offen offset:2176 sc1
  s_mov_b32 s39, 256
L_cpost:
  s_setprio 0
  s_waitcnt vmcnt(6)
  v_cmp_ne_u32 vcc, s7, v71
  s_cbranch_vccz L_ok_7
L_rt_6:
  buffer_load_dwordx4 v[68:71], v83, s[48:51], s35 offen sc1
  s_waitcnt vmcnt(0)
  v_cmp_ne_u32 vcc, s7, v71
  s_add_u32 s88, s88, 1
  s_cmp_gt_u32 s88, 20000
  s_cbranch_scc1 L_end
  s_cbranch_vccnz L_rt_6
L_ok_7:
  v_mov_b32 v72, v70
  s_nop 1
  v_max_u32_dpp v72, v72, v72 quad_perm:[1,0,3,2] row_mask:0xf bank_mask:0xf
  s_nop 1
  v_max_u32_dpp v72, v72, v72 quad_perm:[2,3,0,1] row_mask:0xf bank_mask:0xf
  s_nop 1
  v_max_u32_dpp v72, v72, v72 row_half_mirror row_mask:0xf bank_mask:0xf
  s_nop 1
  v_max_u32_dpp v72, v72, v72 row_mirror row_mask:0xf bank_mask:0xf
  v_mov_b32 v73, v72
  s_nop 1
  v_permlane16_swap_b32 v72, v73
  v_max_u32 v72, v72, v73
  v_mov_b32 v73, v72
  s_nop 1
  v_permlane32_swap_b32 v72, v73
  v_max_u32 v72, v72, v73
  s_lshl_b32 s20, s5, 4
  s_add_u32 s20, s20, 155792
  v_mov_b32 v2, s20
  v_cmp_eq_u32 vcc, v72, v70
  s_nop 0
  s_mov_b64 exec, vcc
  ds_write_b128 v2, v[68:71]
  s_mov_b64 exec, -1
  v_and_b32 v4, 3, v1
  v_lshlrev_b32 v4, 4, v4
  v_add_u32 v4, 155792, v4
  v_add_u32 v2, 65536, v81
  v_add_u32 v3, s39, v2
  v_and_b32 v72, 7, v1
  v_lshlrev_b32 v72, 2, v72
  v_mov_b32 v74, v80
  s_waitcnt lgkmcnt(0)
  s_barrier
  ds_read_b128 v[160:163], v4
  ds_write_b128 v2, v[128:131]
  ds_write_b128 v3, v[132:135]
  ds_write_b128 v2, v[136:139] offset:4096
  ds_write_b128 v3, v[140:143] offset:4096
  s_waitcnt lgkmcnt(4)
  v_mov_b32 v5, v162
  s_nop 1
  v_max_u32_dpp v5, v5, v5 quad_perm:[1,0,3,2] row_mask:0xf bank_mask:0xf
  s_nop 1
  v_max_u32_dpp v5, v5, v5 quad_perm:[2,3,0,1] row_mask:0xf bank_mask:0xf
  v_cmp_eq_u32 vcc, v5, v162
  v_readfirstlane_b32 s9, v5
  s_ff1_i32_b32 s20, vcc_lo
  v_readlane_b32 s18, v160, s20
  v_readlane_b32 s19, v161, s20
  s_and_b32 s24, s9, 0x7ff
  s_sub_u32 s24, 2047, s24
  s_lshl_b32 s24, s24, 10
  s_and_b32 s25, s8, 7
  s_lshl_b32 s25, s25, 7
  s_add_u32 s24, s24, s25
  s_lshl_b32 s25, s5, 5
  s_add_u32 s24, s24, s25
  buffer_load_dword v73, v72, s[40:43], s24 offen
  s_cmp_ge_u32 s4, 4
  s_cselect_b64 s[20:21], -1, 0
  v_cndmask_b32_e64 v248, v224, v226, s[20:21]
  v_cndmask_b32_e64 v249, v225, v227, s[20:21]
  v_bfe_u32 v4, v1, 4, 1
  v_lshlrev_b32 v4, 6, v4
  v_xor_b32 v2, v246, v4
  ds_write_b128 v2, v[208:211] offset:0
  ds_write_b128 v2, v[212:215] offset:1024
  ds_write_b128 v2, v[216:219] offset:2048
  ds_write_b128 v2, v[220:223] offset:3072
  v_mov_b32 v16, 0x3f803f80
  v_mov_b32 v17, v16
  v_mov_b32 v18, v16
  v_mov_b32 v19, v16
  v_mov_b32 v28, v16
  v_mov_b32 v29, v16
  v_mov_b32 v30, v16
  v_mov_b32 v31, v16
  v_mov_b32 v40, v16
  v_mov_b32 v41, v16
  v_mov_b32 v42, v16
  v_mov_b32 v43, v16
  v_mov_b32 v52, v16
  v_mov_b32 v53, v16
  v_mov_b32 v54, v16
  v_mov_b32 v55, v16
  s_waitcnt vmcnt(1)
  buffer_load_dwordx4 v[8:11], v242, s[48:51], s90 offen sc1
  buffer_load_dwordx4 v[20:23], v242, s[48:51], s91 offen sc1
  buffer_load_dwordx4 v[32:35], v242, s[48:51], s92 offen sc1
  buffer_load_dwordx4 v[44:47], v242, s[48:51], s93 offen sc1
  buffer_load_dwordx2 v[80:81], v244, s[48:51], s94 offen sc1
  buffer_load_dwordx2 v[82:83], v244, s[48:51], s95 offen sc1
  s_waitcnt vmcnt(6)
  v_lshlrev_b32 v2, 16, v73
  v_and_b32 v3, 0xffff0000, v73
  v_subrev_f32 v2, s18, v2
  v_subrev_f32 v3, s18, v3
  v_cvt_pk_bf16_f32 v4, v2, v3
  v_lshlrev_b32 v2, 16, v4
  v_and_b32 v3, 0xffff0000, v4
  v_mul_f32 v2, s19, v2
  v_mul_f32 v3, s19, v3
  v_cvt_pk_bf16_f32 v4, v2, v3
  s_add_u32 s25, s25, 156672
  v_add_u32 v72, s25, v72
  ds_write_b32 v72, v4
  v_mov_b32 v75, v93
L_join:
  s_setprio 0
  s_waitcnt lgkmcnt(0)
  s_barrier
  s_lshl_b32 s20, s15, 12
  s_add_u32 s21, s20, 147456
  s_xor_b32 s20, s20, 4096
  s_add_u32 s20, s20, 147456
  v_add_u32 v2, s21, v242
  v_add_u32 v3, s20, v242
  ds_read_b128 v[88:91], v2
  ds_read_b128 v[92:95], v3
  s_cmp_lg_u32 s15, 0
  s_cbranch_scc1 L_noown_8
  v_add_u32 v2, 65536, v242
  v_and_b32 v4, 3, v1
  v_lshlrev_b32 v4, 4, v4
  v_add_u32 v4, 155792, v4
  ds_read_b128 v[160:163], v4
  ds_read_b128 v[56:59], v2
  ds_read_b128 v[68:71], v2 offset:4096
  ds_read_b128 v[60:63], v2 offset:8192
  ds_read_b128 v[72:75], v2 offset:12288
  s_branch L_noown2_9
L_noown_8:
  buffer_load_dwordx4 v[12:15], v243, s[48:51], s90 offen sc1
  buffer_load_dwordx4 v[24:27], v243, s[48:51], s91 offen sc1
  buffer_load_dwordx4 v[36:39], v243, s[48:51], s92 offen sc1
  buffer_load_dwordx4 v[48:51], v243, s[48:51], s93 offen sc1
  buffer_load_dwordx2 v[84:85], v244, s[48:51], s94 offen offset:2048 sc1
  buffer_load_dwordx2 v[86:87], v244, s[48:51], s95 offen offset:2048 sc1
  s_cmp_ge_u32 s89, 176
  s_cbranch_scc1 L_noown2_9
  s_cmp_ge_u32 s5, 2
  s_cbranch_scc1 L_noown2_9
  v_lshrrev_b32 v2, 5, v1
  v_lshlrev_b32 v2, 4, v2
  v_add_u32 v2, 156672, v2
  ds_read_b128 v[144:147], v2 offset:0
  ds_read_b128 v[148:151], v2 offset:32
  ds_read_b128 v[152:155], v2 offset:64
  ds_read_b128 v[156:159], v2 offset:96
  ds_read_b64_tr_b16 v[160:161], v75 offset:16384
  ds_read_b64_tr_b16 v[162:163], v75 offset:16896
  ds_read_b64_tr_b16 v[164:165], v75 offset:17408
  ds_read_b64_tr_b16 v[166:167], v75 offset:17920
  ds_read_b64_tr_b16 v[168:169], v75 offset:20480
  ds_read_b64_tr_b16 v[170:171], v75 offset:20992
  ds_read_b64_tr_b16 v[172:173], v75 offset:21504
  ds_read_b64_tr_b16 v[174:175], v75 offset:22016
  ds_read_b64_tr_b16 v[176:177], v75 offset:24576
  ds_read_b64_tr_b16 v[178:179], v75 offset:25088
  ds_read_b64_tr_b16 v[180:181], v75 offset:25600
  ds_read_b64_tr_b16 v[182:183], v75 offset:26112
  ds_read_b64_tr_b16 v[184:185], v75 offset:28672
  ds_read_b64_tr_b16 v[186:187], v75 offset:29184
  ds_read_b64_tr_b16 v[188:189], v75 offset:29696
  ds_read_b64_tr_b16 v[190:191], v75 offset:30208
L_noown2_9:
  s_waitcnt lgkmcnt(0)
  s_cmp_eq_u32 s15, 0
  s_cbranch_scc1 L_fA
  s_cmp_ge_u32 s89, 176
  s_cbranch_scc1 L_nog_10
  s_cmp_ge_u32 s5, 2
  s_cbranch_scc1 L_nog_10
  v_mfma_f32_32x32x16_bf16 v[96:111], v[144:147], v[160:163], 0
  v_mfma_f32_32x32x16_bf16 v[112:127], v[144:147], v[164:167], 0
  v_mfma_f32_32x32x16_bf16 v[96:111], v[148:151], v[168:171], v[96:111]
  v_mfma_f32_32x32x16_bf16 v[112:127], v[148:151], v[172:175], v[112:127]
  v_mfma_f32_32x32x16_bf16 v[96:111], v[152:155], v[176:179], v[96:111]
  v_mfma_f32_32x32x16_bf16 v[112:127], v[152:155], v[180:183], v[112:127]
  v_mfma_f32_32x32x16_bf16 v[96:111], v[156:159], v[184:187], v[96:111]
  v_mfma_f32_32x32x16_bf16 v[112:127], v[156:159], v[188:191], v[112:127]
  s_and_b32 s20, s8, 7
  s_mul_i32 s20, s20, 22528
  s_lshr_b32 s21, s89, 3
  s_lshl_b32 s21, s21, 10
  s_add_u32 s20, s20, s21
  s_lshl_b32 s21, s5, 9
  s_add_u32 s20, s20, s21
  s_add_u32 s20, s20, 262144
  v_mov_b32 v210, s7
  v_mov_b32 v211, s7
  s_mov_b32 s22, -1
  s_mov_b32 s23, 0
  v_mov_b32 v208, v96
  v_mov_b32 v209, v112
  s_mov_b64 exec, s[22:23]
  buffer_store_dwordx4 v[208:211], v74, s[48:51], s20 offen sc1
  s_mov_b64 exec, -1
  s_branch L_nog2_11
L_nog_10:
  s_mov_b32 s20, 0x40000000
  buffer_load_dword v254, v74, s[48:51], s20 offen
L_nog2_11:
  s_waitcnt vmcnt(7)
  v_add3_u32 v2, v8, v9, v10
  v_add3_u32 v2, v2, v11, s7
  v_xor_b32 v2, v2, v80
  v_add3_u32 v3, v20, v21, v22
  v_add3_u32 v3, v3, v23, s7
  v_xor_b32 v3, v3, v81
  v_add3_u32 v4, v32, v33, v34
  v_add3_u32 v4, v4, v35, s7
  v_xor_b32 v4, v4, v82
  v_add3_u32 v5, v44, v45, v46
  v_add3_u32 v5, v5, v47, s7
  v_xor_b32 v5, v5, v83
  v_or_b32 v2, v2, v3
  v_or_b32 v4, v4, v5
  v_and_b32 v2, s16, v2
  v_and_or_b32 v2, v4, s17, v2
  v_cmp_ne_u32 vcc, 0, v2
  s_cbranch_vccz L_ok_13
L_rt_12:
  buffer_load_dwordx4 v[8:11], v242, s[48:51], s90 offen sc1
  buffer_load_dwordx4 v[20:23], v242, s[48:51], s91 offen sc1
  buffer_load_dwordx4 v[32:35], v242, s[48:51], s92 offen sc1
  buffer_load_dwordx4 v[44:47], v242, s[48:51], s93 offen sc1
  buffer_load_dwordx2 v[80:81], v244, s[48:51], s94 offen sc1
  buffer_load_dwordx2 v[82:83], v244, s[48:51], s95 offen sc1
  buffer_load_dwordx4 v[12:15], v243, s[48:51], s90 offen sc1
  buffer_load_dwordx4 v[24:27], v243, s[48:51], s91 offen sc1
  buffer_load_dwordx4 v[36:39], v243, s[48:51], s92 offen sc1
  buffer_load_dwordx4 v[48:51], v243, s[48:51], s93 offen sc1
  buffer_load_dwordx2 v[84:85], v244, s[48:51], s94 offen offset:2048 sc1
  buffer_load_dwordx2 v[86:87], v244, s[48:51], s95 offen offset:2048 sc1
  s_waitcnt vmcnt(0)
  v_add3_u32 v2, v8, v9, v10
  v_add3_u32 v2, v2, v11, s7
  v_xor_b32 v2, v2, v80
  v_add3_u32 v3, v20, v21, v22
  v_add3_u32 v3, v3, v23, s7
  v_xor_b32 v3, v3, v81
  v_add3_u32 v4, v32, v33, v34
  v_add3_u32 v4, v4, v35, s7
  v_xor_b32 v4, v4, v82
  v_add3_u32 v5, v44, v45, v46
  v_add3_u32 v5, v5, v47, s7
  v_xor_b32 v5, v5, v83
  v_or_b32 v2, v2, v3
  v_or_b32 v4, v4, v5
  v_and_b32 v2, s16, v2
  v_and_or_b32 v2, v4, s17, v2
  v_cmp_ne_u32 vcc, 0, v2
  s_add_u32 s88, s88, 1
  s_cmp_gt_u32 s88, 20000
  s_cbranch_scc1 L_end
  s_cbranch_vccnz L_rt_12
L_ok_13:
  s_cmp_eq_u32 s16, 0
  s_cbranch_scc1 L_fb1_14
  v_mfma_f32_32x32x16_bf16 v[160:175], v[8:11], v[88:91], 0
  v_mfma_f32_32x32x16_bf16 v[176:191], v[8:11], v[92:95], 0
  s_nop 10
  v_exp_f32 v160, v160
  v_exp_f32 v161, v161
  v_exp_f32 v162, v162
  v_exp_f32 v163, v163
  v_exp_f32 v164, v164
  v_exp_f32 v165, v165
  v_exp_f32 v166, v166
  v_exp_f32 v167, v167
  v_exp_f32 v168, v168
  v_exp_f32 v169, v169
  v_exp_f32 v170, v170
  v_exp_f32 v171, v171
  v_exp_f32 v172, v172
  v_exp_f32 v173, v173
  v_exp_f32 v174, v174
  v_exp_f32 v175, v175
  v_cvt_pk_bf16_f32 v160, v160, v161
  v_cvt_pk_bf16_f32 v161, v162, v163
  v_cvt_pk_bf16_f32 v162, v164, v165
  v_cvt_pk_bf16_f32 v163, v166, v167
  v_cvt_pk_bf16_f32 v164, v168, v169
  v_cvt_pk_bf16_f32 v165, v170, v171
  v_cvt_pk_bf16_f32 v166, v172, v173
  v_cvt_pk_bf16_f32 v167, v174, v175
  s_waitcnt vmcnt(1)
  v_add3_u32 v2, v12, v13, v14
  v_add3_u32 v2, v2, v15, s7
  v_xor_b32 v2, v2, v84
  v_add3_u32 v3, v24, v25, v26
  v_add3_u32 v3, v3, v27, s7
  v_xor_b32 v3, v3, v85
  v_add3_u32 v4, v36, v37, v38
  v_add3_u32 v4, v4, v39, s7
  v_xor_b32 v4, v4, v86
  v_add3_u32 v5, v48, v49, v50
  v_add3_u32 v5, v5, v51, s7
  v_xor_b32 v5, v5, v87
  v_or_b32 v2, v2, v3
  v_or_b32 v4, v4, v5
  v_and_b32 v2, s16, v2
  v_and_or_b32 v2, v4, s17, v2
  v_cmp_ne_u32 vcc, 0, v2
  s_cbranch_vccz L_ok_17
L_rt_16:
  buffer_load_dwordx4 v[12:15], v243, s[48:51], s90 offen sc1
  buffer_load_dwordx4 v[24:27], v243, s[48:51], s91 offen sc1
  buffer_load_dwordx4 v[36:39], v243, s[48:51], s92 offen sc1
  buffer_load_dwordx4 v[48:51], v243, s[48:51], s93 offen sc1
  buffer_load_dwordx2 v[84:85], v244, s[48:51], s94 offen offset:2048 sc1
  buffer_load_dwordx2 v[86:87], v244, s[48:51], s95 offen offset:2048 sc1
  s_waitcnt vmcnt(0)
  v_add3_u32 v2, v12, v13, v14
  v_add3_u32 v2, v2, v15, s7
  v_xor_b32 v2, v2, v84
  v_add3_u32 v3, v24, v25, v26
  v_add3_u32 v3, v3, v27, s7
  v_xor_b32 v3, v3, v85
  v_add3_u32 v4, v36, v37, v38
  v_add3_u32 v4, v4, v39, s7
  v_xor_b32 v4, v4, v86
  v_add3_u32 v5, v48, v49, v50
  v_add3_u32 v5, v5, v51, s7
  v_xor_b32 v5, v5, v87
  v_or_b32 v2, v2, v3
  v_or_b32 v4, v4, v5
  v_and_b32 v2, s16, v2
  v_and_or_b32 v2, v4, s17, v2
  v_cmp_ne_u32 vcc, 0, v2
  s_add_u32 s88, s88, 1
  s_cmp_gt_u32 s88, 20000
  s_cbranch_scc1 L_end
  s_cbranch_vccnz L_rt_16
L_ok_17:
  v_permlane16_swap_b32 v12, v16
  v_permlane16_swap_b32 v13, v17
  v_permlane16_swap_b32 v14, v18
  v_permlane16_swap_b32 v15, v19
  v_permlane16_swap_b32 v24, v28
  v_permlane16_swap_b32 v25, v29
  v_permlane16_swap_b32 v26, v30
  v_permlane16_swap_b32 v27, v31
  v_permlane16_swap_b32 v36, v40
  v_permlane16_swap_b32 v37, v41
  v_permlane16_swap_b32 v38, v42
  v_permlane16_swap_b32 v39, v43
  v_permlane16_swap_b32 v48, v52
  v_permlane16_swap_b32 v49, v53
  v_permlane16_swap_b32 v50, v54
  v_permlane16_swap_b32 v51, v55
  buffer_load_dwordx4 v[80:83], v247, s[40:43], s80 offen offset:0
  buffer_load_dwordx4 v[84:87], v247, s[40:43], s80 offen offset:32
  v_mfma_f32_32x32x16_bf16 v[192:207], v[20:23], v[88:91], 0
  v_exp_f32 v176, v176
  v_exp_f32 v177, v177
  v_exp_f32 v178, v178
  v_exp_f32 v179, v179
  v_exp_f32 v180, v180
  v_mfma_f32_32x32x16_bf16 v[128:143], v[12:15], v[160:163], 0
  v_exp_f32 v181, v181
  v_exp_f32 v182, v182
  v_exp_f32 v183, v183
  v_exp_f32 v184, v184
  v_exp_f32 v185, v185
  v_mfma_f32_32x32x16_bf16 v[128:143], v[16:19], v[164:167], v[128:143]
  v_exp_f32 v186, v186
  v_exp_f32 v187, v187
  v_exp_f32 v188, v188
  v_exp_f32 v189, v189
  v_exp_f32 v190, v190
  v_exp_f32 v191, v191
  v_cvt_pk_bf16_f32 v176, v176, v177
  v_cvt_pk_bf16_f32 v177, v178, v179
  v_cvt_pk_bf16_f32 v178, v180, v181
  v_cvt_pk_bf16_f32 v179, v182, v183
  v_cvt_pk_bf16_f32 v180, v184, v185
  v_cvt_pk_bf16_f32 v181, v186, v187
  v_cvt_pk_bf16_f32 v182, v188, v189
  v_cvt_pk_bf16_f32 v183, v190, v191
  v_mfma_f32_32x32x16_bf16 v[160:175], v[20:23], v[92:95], 0
  v_exp_f32 v192, v192
  v_exp_f32 v193, v193
  v_exp_f32 v194, v194
  v_exp_f32 v195, v195
  v_exp_f32 v196, v196
  v_mfma_f32_32x32x16_bf16 v[144:159], v[12:15], v[176:179], 0
  v_exp_f32 v197, v197
  v_exp_f32 v198, v198
  v_exp_f32 v199, v199
  v_exp_f32 v200, v200
  v_exp_f32 v201, v201
  v_mfma_f32_32x32x16_bf16 v[144:159], v[16:19], v[180:183], v[144:159]
  v_exp_f32 v202, v202
  v_exp_f32 v203, v203
  v_exp_f32 v204, v204
  v_exp_f32 v205, v205
  v_exp_f32 v206, v206
  v_exp_f32 v207, v207
  v_cvt_pk_bf16_f32 v192, v192, v193
  v_cvt_pk_bf16_f32 v193, v194, v195
  v_cvt_pk_bf16_f32 v194, v196, v197
  v_cvt_pk_bf16_f32 v195, v198, v199
  v_cvt_pk_bf16_f32 v196, v200, v201
  v_cvt_pk_bf16_f32 v197, v202, v203
  v_cvt_pk_bf16_f32 v198, v204, v205
  v_cvt_pk_bf16_f32 v199, v206, v207
  v_mfma_f32_32x32x16_bf16 v[176:191], v[32:35], v[88:91], 0
  v_exp_f32 v160, v160
  v_exp_f32 v161, v161
  v_exp_f32 v162, v162
  v_exp_f32 v163, v163
  v_exp_f32 v164, v164
  v_mfma_f32_32x32x16_bf16 v[128:143], v[24:27], v[192:195], v[128:143]
  v_exp_f32 v165, v165
  v_exp_f32 v166, v166
  v_exp_f32 v167, v167
  v_exp_f32 v168, v168
  v_exp_f32 v169, v169
  v_mfma_f32_32x32x16_bf16 v[128:143], v[28:31], v[196:199], v[128:143]
  v_exp_f32 v170, v170
  v_exp_f32 v171, v171
  v_exp_f32 v172, v172
  v_exp_f32 v173, v173
  v_exp_f32 v174, v174
  v_exp_f32 v175, v175
  v_cvt_pk_bf16_f32 v160, v160, v161
  v_cvt_pk_bf16_f32 v161, v162, v163
  v_cvt_pk_bf16_f32 v162, v164, v165
  v_cvt_pk_bf16_f32 v163, v166, v167
  v_cvt_pk_bf16_f32 v164, v168, v169
  v_cvt_pk_bf16_f32 v165, v170, v171
  v_cvt_pk_bf16_f32 v166, v172, v173
  v_cvt_pk_bf16_f32 v167, v174, v175
  v_mfma_f32_32x32x16_bf16 v[192:207], v[32:35], v[92:95], 0
  v_exp_f32 v176, v176
  v_exp_f32 v177, v177
  v_exp_f32 v178, v178
  v_exp_f32 v179, v179
  v_exp_f32 v180, v180
  v_mfma_f32_32x32x16_bf16 v[144:159], v[24:27], v[160:163], v[144:159]
  v_exp_f32 v181, v181
  v_exp_f32 v182, v182
  v_exp_f32 v183, v183
  v_exp_f32 v184, v184
  v_exp_f32 v185, v185
  v_mfma_f32_32x32x16_bf16 v[144:159], v[28:31], v[164:167], v[144:159]
  v_exp_f32 v186, v186
  v_exp_f32 v187, v187
  v_exp_f32 v188, v188
  v_exp_f32 v189, v189
  v_exp_f32 v190, v190
  v_exp_f32 v191, v191
  v_cvt_pk_bf16_f32 v176, v176, v177
  v_cvt_pk_bf16_f32 v177, v178, v179
  v_cvt_pk_bf16_f32 v178, v180, v181
  v_cvt_pk_bf16_f32 v179, v182, v183
  v_cvt_pk_bf16_f32 v180, v184, v185
  v_cvt_pk_bf16_f32 v181, v186, v187
  v_cvt_pk_bf16_f32 v182, v188, v189
  v_cvt_pk_bf16_f32 v183, v190, v191
  v_mfma_f32_32x32x16_bf16 v[160:175], v[44:47], v[88:91], 0
  v_exp_f32 v192, v192
  v_exp_f32 v193, v193
  v_exp_f32 v194, v194
  v_exp_f32 v195, v195
  v_exp_f32 v196, v196
  v_mfma_f32_32x32x16_bf16 v[128:143], v[36:39], v[176:179], v[128:143]
  v_exp_f32 v197, v197
  v_exp_f32 v198, v198
  v_exp_f32 v199, v199
  v_exp_f32 v200, v200
  v_exp_f32 v201, v201
  v_mfma_f32_32x32x16_bf16 v[128:143], v[40:43], v[180:183], v[128:143]
  v_exp_f32 v202, v202
  v_exp_f32 v203, v203
  v_exp_f32 v204, v204
  v_exp_f32 v205, v205
  v_exp_f32 v206, v206
  v_exp_f32 v207, v207
  v_cvt_pk_bf16_f32 v192, v192, v193
  v_cvt_pk_bf16_f32 v193, v194, v195
  v_cvt_pk_bf16_f32 v194, v196, v197
  v_cvt_pk_bf16_f32 v195, v198, v199
  v_cvt_pk_bf16_f32 v196, v200, v201
  v_cvt_pk_bf16_f32 v197, v202, v203
  v_cvt_pk_bf16_f32 v198, v204, v205
  v_cvt_pk_bf16_f32 v199, v206, v207
  v_mfma_f32_32x32x16_bf16 v[176:191], v[44:47], v[92:95], 0
  v_exp_f32 v160, v160
  v_exp_f32 v161, v161
  v_exp_f32 v162, v162
  v_exp_f32 v163, v163
  v_exp_f32 v164, v164
  v_mfma_f32_32x32x16_bf16 v[144:159], v[36:39], v[192:195], v[144:159]
  v_exp_f32 v165, v165
  v_exp_f32 v166, v166
  v_exp_f32 v167, v167
  v_exp_f32 v168, v168
  v_exp_f32 v169, v169
  v_mfma_f32_32x32x16_bf16 v[144:159], v[40:43], v[196:199], v[144:159]
  v_exp_f32 v170, v170
  v_exp_f32 v171, v171
  v_exp_f32 v172, v172
  v_exp_f32 v173, v173
  v_exp_f32 v174, v174
  v_exp_f32 v175, v175
  v_cvt_pk_bf16_f32 v160, v160, v161
  v_cvt_pk_bf16_f32 v161, v162, v163
  v_cvt_pk_bf16_f32 v162, v164, v165
  v_cvt_pk_bf16_f32 v163, v166, v167
  v_cvt_pk_bf16_f32 v164, v168, v169
  v_cvt_pk_bf16_f32 v165, v170, v171
  v_cvt_pk_bf16_f32 v166, v172, v173
  v_cvt_pk_bf16_f32 v167, v174, v175
  v_mfma_f32_32x32x16_bf16 v[128:143], v[48:51], v[160:163], v[128:143]
  v_exp_f32 v176, v176
  v_exp_f32 v177, v177
  v_exp_f32 v178, v178
  v_exp_f32 v179, v179
  v_exp_f32 v180, v180
  v_mfma_f32_32x32x16_bf16 v[128:143], v[52:55], v[164:167], v[128:143]
  v_exp_f32 v181, v181
  v_exp_f32 v182, v182
  v_exp_f32 v183, v183
  v_exp_f32 v184, v184
  v_exp_f32 v185, v185
  v_exp_f32 v186, v186
  v_exp_f32 v187, v187
  v_exp_f32 v188, v188
  v_exp_f32 v189, v189
  v_exp_f32 v190, v190
  v_exp_f32 v191, v191
  v_cvt_pk_bf16_f32 v176, v176, v177
  v_cvt_pk_bf16_f32 v177, v178, v179
  v_cvt_pk_bf16_f32 v178, v180, v181
  v_cvt_pk_bf16_f32 v179, v182, v183
  v_cvt_pk_bf16_f32 v180, v184, v185
  v_cvt_pk_bf16_f32 v181, v186, v187
  v_cvt_pk_bf16_f32 v182, v188, v189
  v_cvt_pk_bf16_f32 v183, v190, v191
  v_mfma_f32_32x32x16_bf16 v[144:159], v[48:51], v[176:179], v[144:159]
  s_nop 0
  v_mfma_f32_32x32x16_bf16 v[144:159], v[52:55], v[180:183], v[144:159]
  s_branch L_fchk
L_fb1_14:
  s_cmp_eq_u32 s17, 0
  s_cbranch_scc1 L_fb0_15
  v_mfma_f32_32x32x16_bf16 v[160:175], v[32:35], v[88:91], 0
  v_mfma_f32_32x32x16_bf16 v[176:191], v[32:35], v[92:95], 0
  s_nop 10
  v_exp_f32 v160, v160
  v_exp_f32 v161, v161
  v_exp_f32 v162, v162
  v_exp_f32 v163, v163
  v_exp_f32 v164, v164
  v_exp_f32 v165, v165
  v_exp_f32 v166, v166
  v_exp_f32 v167, v167
  v_exp_f32 v168, v168
  v_exp_f32 v169, v169
  v_exp_f32 v170, v170
  v_exp_f32 v171, v171
  v_exp_f32 v172, v172
  v_exp_f32 v173, v173
  v_exp_f32 v174, v174
  v_exp_f32 v175, v175
  v_cvt_pk_bf16_f32 v160, v160, v161
  v_cvt_pk_bf16_f32 v161, v162, v163
  v_cvt_pk_bf16_f32 v162, v164, v165
  v_cvt_pk_bf16_f32 v163, v166, v167
  v_cvt_pk_bf16_f32 v164, v168, v169
  v_cvt_pk_bf16_f32 v165, v170, v171
  v_cvt_pk_bf16_f32 v166, v172, v173
  v_cvt_pk_bf16_f32 v167, v174, v175
  s_waitcnt vmcnt(1)
  v_add3_u32 v2, v12, v13, v14
  v_add3_u32 v2, v2, v15, s7
  v_xor_b32 v2, v2, v84
  v_add3_u32 v3, v24, v25, v26
  v_add3_u32 v3, v3, v27, s7
  v_xor_b32 v3, v3, v85
  v_add3_u32 v4, v36, v37, v38
  v_add3_u32 v4, v4, v39, s7
  v_xor_b32 v4, v4, v86
  v_add3_u32 v5, v48, v49, v50
  v_add3_u32 v5, v5, v51, s7
  v_xor_b32 v5, v5, v87
  v_or_b32 v2, v2, v3
  v_or_b32 v4, v4, v5
  v_and_b32 v2, s16, v2
  v_and_or_b32 v2, v4, s17, v2
  v_cmp_ne_u32 vcc, 0, v2
  s_cbranch_vccz L_ok_19
L_rt_18:
  buffer_load_dwordx4 v[12:15], v243, s[48:51], s90 offen sc1
  buffer_load_dwordx4 v[24:27], v243, s[48:51], s91 offen sc1
  buffer_load_dwordx4 v[36:39], v243, s[48:51], s92 offen sc1
  buffer_load_dwordx4 v[48:51], v243, s[48:51], s93 offen sc1
  buffer_load_dwordx2 v[84:85], v244, s[48:51], s94 offen offset:2048 sc1
  buffer_load_dwordx2 v[86:87], v244, s[48:51], s95 offen offset:2048 sc1
  s_waitcnt vmcnt(0)
  v_add3_u32 v2, v12, v13, v14
  v_add3_u32 v2, v2, v15, s7
  v_xor_b32 v2, v2, v84
  v_add3_u32 v3, v24, v25, v26
  v_add3_u32 v3, v3, v27, s7
  v_xor_b32 v3, v3, v85
  v_add3_u32 v4, v36, v37, v38
  v_add3_u32 v4, v4, v39, s7
  v_xor_b32 v4, v4, v86
  v_add3_u32 v5, v48, v49, v50
  v_add3_u32 v5, v5, v51, s7
  v_xor_b32 v5, v5, v87
  v_or_b32 v2, v2, v3
  v_or_b32 v4, v4, v5
  v_and_b32 v2, s16, v2
  v_and_or_b32 v2, v4, s17, v2
  v_cmp_ne_u32 vcc, 0, v2
  s_add_u32 s88, s88, 1
  s_cmp_gt_u32 s88, 20000
  s_cbranch_scc1 L_end
  s_cbranch_vccnz L_rt_18
L_ok_19:
  v_permlane16_swap_b32 v12, v16
  v_permlane16_swap_b32 v13, v17
  v_permlane16_swap_b32 v14, v18
  v_permlane16_swap_b32 v15, v19
  v_permlane16_swap_b32 v24, v28
  v_permlane16_swap_b32 v25, v29
  v_permlane16_swap_b32 v26, v30
  v_permlane16_swap_b32 v27, v31
  v_permlane16_swap_b32 v36, v40
  v_permlane16_swap_b32 v37, v41
  v_permlane16_swap_b32 v38, v42
  v_permlane16_swap_b32 v39, v43
  v_permlane16_swap_b32 v48, v52
  v_permlane16_swap_b32 v49, v53
  v_permlane16_swap_b32 v50, v54
  v_permlane16_swap_b32 v51, v55
  buffer_load_dwordx4 v[80:83], v247, s[40:43], s80 offen offset:0
  buffer_load_dwordx4 v[84:87], v247, s[40:43], s80 offen offset:32
  s_cmp_ge_u32 s85, 43
  s_cbranch_scc1 L_nwd_20
  s_lshl_b32 s37, s85, 15
  s_lshl_b32 s20, s14, 8
  s_add_u32 s37, s37, s20
  v_lshrrev_b32 v2, 4, v1
  v_and_b32 v3, 15, v1
  v_lshlrev_b32 v3, 4, v3
  v_lshl_add_u32 v2, v2, 10, v3
  buffer_load_dwordx4 v[96:99], v2, s[76:79], s37 offen nt
  s_add_u32 s37, s37, 4096
  buffer_load_dwordx4 v[100:103], v2, s[76:79], s37 offen nt
  s_add_u32 s37, s37, 4096
  buffer_load_dwordx4 v[104:107], v2, s[76:79], s37 offen nt
  s_add_u32 s37, s37, 4096
  buffer_load_dwordx4 v[108:111], v2, s[76:79], s37 offen nt
  s_add_u32 s37, s37, 4096
  buffer_load_dwordx4 v[112:115], v2, s[76:79], s37 offen nt
  s_add_u32 s37, s37, 4096
  buffer_load_dwordx4 v[116:119], v2, s[76:79], s37 offen nt
  s_add_u32 s37, s37, 4096
  buffer_load_dwordx4 v[120:123], v2, s[76:79], s37 offen nt
  s_add_u32 s37, s37, 4096
  buffer_load_dwordx4 v[124:127], v2, s[76:79], s37 offen nt
  s_add_u32 s37, s37, 4096
L_nwd_20:
  v_mfma_f32_32x32x16_bf16 v[192:207], v[44:47], v[88:91], 0
  v_exp_f32 v176, v176
  v_exp_f32 v177, v177
  v_exp_f32 v178, v178
  v_exp_f32 v179, v179
  v_exp_f32 v180, v180
  v_mfma_f32_32x32x16_bf16 v[128:143], v[36:39], v[160:163], 0
  v_exp_f32 v181, v181
  v_exp_f32 v182, v182
  v_exp_f32 v183, v183
  v_exp_f32 v184, v184
  v_exp_f32 v185, v185
  v_mfma_f32_32x32x16_bf16 v[128:143], v[40:43], v[164:167], v[128:143]
  v_exp_f32 v186, v186
  v_exp_f32 v187, v187
  v_exp_f32 v188, v188
  v_exp_f32 v189, v189
  v_exp_f32 v190, v190
  v_exp_f32 v191, v191
  v_cvt_pk_bf16_f32 v176, v176, v177
  v_cvt_pk_bf16_f32 v177, v178, v179
  v_cvt_pk_bf16_f32 v178, v180, v181
  v_cvt_pk_bf16_f32 v179, v182, v183
  v_cvt_pk_bf16_f32 v180, v184, v185
  v_cvt_pk_bf16_f32 v181, v186, v187
  v_cvt_pk_bf16_f32 v182, v188, v189
  v_cvt_pk_bf16_f32 v183, v190, v191
  v_mfma_f32_32x32x16_bf16 v[160:175], v[44:47], v[92:95], 0
  v_exp_f32 v192, v192
  v_exp_f32 v193, v193
  v_exp_f32 v194, v194
  v_exp_f32 v195, v195
  v_exp_f32 v196, v196
  v_mfma_f32_32x32x16_bf16 v[144:159], v[36:39], v[176:179], 0
  v_exp_f32 v197, v197
  v_exp_f32 v198, v198
  v_exp_f32 v199, v199
  v_exp_f32 v200, v200
  v_exp_f32 v201, v201
  v_mfma_f32_32x32x16_bf16 v[144:159], v[40:43], v[180:183], v[144:159]
  v_exp_f32 v202, v202
  v_exp_f32 v203, v203
  v_exp_f32 v204, v204
  v_exp_f32 v205, v205
  v_exp_f32 v206, v206
  v_exp_f32 v207, v207
  v_cvt_pk_bf16_f32 v192, v192, v193
  v_cvt_pk_bf16_f32 v193, v194, v195
  v_cvt_pk_bf16_f32 v194, v196, v197
  v_cvt_pk_bf16_f32 v195, v198, v199
  v_cvt_pk_bf16_f32 v196, v200, v201
  v_cvt_pk_bf16_f32 v197, v202, v203
  v_cvt_pk_bf16_f32 v198, v204, v205
  v_cvt_pk_bf16_f32 v199, v206, v207
  v_mfma_f32_32x32x16_bf16 v[128:143], v[48:51], v[192:195], v[128:143]
  v_exp_f32 v160, v160
  v_exp_f32 v161, v161
  v_exp_f32 v162, v162
  v_exp_f32 v163, v163
  v_exp_f32 v164, v164
  v_mfma_f32_32x32x16_bf16 v[128:143], v[52:55], v[196:199], v[128:143]
  v_exp_f32 v165, v165
  v_exp_f32 v166, v166
  v_exp_f32 v167, v167
  v_exp_f32 v168, v168
  v_exp_f32 v169, v169
  v_exp_f32 v170, v170
  v_exp_f32 v171, v171
  v_exp_f32 v172, v172
  v_exp_f32 v173, v173
  v_exp_f32 v174, v174
  v_exp_f32 v175, v175
  v_cvt_pk_bf16_f32 v160, v160, v161
  v_cvt_pk_bf16_f32 v161, v162, v163
  v_cvt_pk_bf16_f32 v162, v164, v165
  v_cvt_pk_bf16_f32 v163, v166, v167
  v_cvt_pk_bf16_f32 v164, v168, v169
  v_cvt_pk_bf16_f32 v165, v170, v171
  v_cvt_pk_bf16_f32 v166, v172, v173
  v_cvt_pk_bf16_f32 v167, v174, v175
  v_mfma_f32_32x32x16_bf16 v[144:159], v[48:51], v[160:163], v[144:159]
  s_nop 0
  v_mfma_f32_32x32x16_bf16 v[144:159], v[52:55], v[164:167], v[144:159]
L_du_21:
  s_sub_u32 s20, s84, 4
  s_cmp_ge_u32 s13, s20
  s_cbranch_scc1 L_de_22
  s_and_b32 s26, s13, 3
  s_add_u32 s13, s13, 1
  s_lshl_b32 s27, s26, 12
  s_add_u32 m0, s27, s83
  s_lshl_b32 s27, s26, 14
  s_add_u32 s27, s27, s82
  buffer_load_dwordx4 v250, s[60:63], s27 offen offset:0 lds
  buffer_load_dwordx4 v251, s[60:63], s27 offen offset:1024 lds
  buffer_load_dwordx4 v252, s[60:63], s27 offen offset:2048 lds
  buffer_load_dwordx4 v253, s[60:63], s27 offen offset:3072 lds
  s_branch L_du_21
L_de_22:
  s_branch L_fchk
L_fb0_15:
  s_waitcnt vmcnt(1)
  v_add3_u32 v2, v12, v13, v14
  v_add3_u32 v2, v2, v15, s7
  v_xor_b32 v2, v2, v84
  v_add3_u32 v3, v24, v25, v26
  v_add3_u32 v3, v3, v27, s7
  v_xor_b32 v3, v3, v85
  v_add3_u32 v4, v36, v37, v38
  v_add3_u32 v4, v4, v39, s7
  v_xor_b32 v4, v4, v86
  v_add3_u32 v5, v48, v49, v50
  v_add3_u32 v5, v5, v51, s7
  v_xor_b32 v5, v5, v87
  v_or_b32 v2, v2, v3
  v_or_b32 v4, v4, v5
  v_and_b32 v2, s16, v2
  v_and_or_b32 v2, v4, s17, v2
  v_cmp_ne_u32 vcc, 0, v2
  s_cbranch_vccz L_ok_24
L_rt_23:
  buffer_load_dwordx4 v[12:15], v243, s[48:51], s90 offen sc1
  buffer_load_dwordx4 v[24:27], v243, s[48:51], s91 offen sc1
  buffer_load_dwordx4 v[36:39], v243, s[48:51], s92 offen sc1
  buffer_load_dwordx4 v[48:51], v243, s[48:51], s93 offen sc1
  buffer_load_dwordx2 v[84:85], v244, s[48:51], s94 offen offset:2048 sc1
  buffer_load_dwordx2 v[86:87], v244, s[48:51], s95 offen offset:2048 sc1
  s_waitcnt vmcnt(0)
  v_add3_u32 v2, v12, v13, v14
  v_add3_u32 v2, v2, v15, s7
  v_xor_b32 v2, v2, v84
  v_add3_u32 v3, v24, v25, v26
  v_add3_u32 v3, v3, v27, s7
  v_xor_b32 v3, v3, v85
  v_add3_u32 v4, v36, v37, v38
  v_add3_u32 v4, v4, v39, s7
  v_xor_b32 v4, v4, v86
  v_add3_u32 v5, v48, v49, v50
  v_add3_u32 v5, v5, v51, s7
  v_xor_b32 v5, v5, v87
  v_or_b32 v2, v2, v3
  v_or_b32 v4, v4, v5
  v_and_b32 v2, s16, v2
  v_and_or_b32 v2, v4, s17, v2
  v_cmp_ne_u32 vcc, 0, v2
  s_add_u32 s88, s88, 1
  s_cmp_gt_u32 s88, 20000
  s_cbranch_scc1 L_end
  s_cbranch_vccnz L_rt_23
L_ok_24:
  v_permlane16_swap_b32 v12, v16
  v_permlane16_swap_b32 v13, v17
  v_permlane16_swap_b32 v14, v18
  v_permlane16_swap_b32 v15, v19
  v_permlane16_swap_b32 v24, v28
  v_permlane16_swap_b32 v25, v29
  v_permlane16_swap_b32 v26, v30
  v_permlane16_swap_b32 v27, v31
  v_permlane16_swap_b32 v36, v40
  v_permlane16_swap_b32 v37, v41
  v_permlane16_swap_b32 v38, v42
  v_permlane16_swap_b32 v39, v43
  v_permlane16_swap_b32 v48, v52
  v_permlane16_swap_b32 v49, v53
  v_permlane16_swap_b32 v50, v54
  v_permlane16_swap_b32 v51, v55
  buffer_load_dwordx4 v[80:83], v247, s[40:43], s80 offen offset:0
  buffer_load_dwordx4 v[84:87], v247, s[40:43], s80 offen offset:32
  s_cmp_ge_u32 s85, 43
  s_cbranch_scc1 L_nwd_25
  s_lshl_b32 s37, s85, 15
  s_lshl_b32 s20, s14, 8
  s_add_u32 s37, s37, s20
  v_lshrrev_b32 v2, 4, v1
  v_and_b32 v3, 15, v1
  v_lshlrev_b32 v3, 4, v3
  v_lshl_add_u32 v2, v2, 10, v3
  buffer_load_dwordx4 v[96:99], v2, s[76:79], s37 offen nt
  s_add_u32 s37, s37, 4096
  buffer_load_dwordx4 v[100:103], v2, s[76:79], s37 offen nt
  s_add_u32 s37, s37, 4096
  buffer_load_dwordx4 v[104:107], v2, s[76:79], s37 offen nt
  s_add_u32 s37, s37, 4096
  buffer_load_dwordx4 v[108:111], v2, s[76:79], s37 offen nt
  s_add_u32 s37, s37, 4096
  buffer_load_dwordx4 v[112:115], v2, s[76:79], s37 offen nt
  s_add_u32 s37, s37, 4096
  buffer_load_dwordx4 v[116:119], v2, s[76:79], s37 offen nt
  s_add_u32 s37, s37, 4096
  buffer_load_dwordx4 v[120:123], v2, s[76:79], s37 offen nt
  s_add_u32 s37, s37, 4096
  buffer_load_dwordx4 v[124:127], v2, s[76:79], s37 offen nt
  s_add_u32 s37, s37, 4096
L_nwd_25:
L_du_26:
  s_sub_u32 s20, s84, 4
  s_cmp_ge_u32 s13, s20
  s_cbranch_scc1 L_de_27
  s_and_b32 s26, s13, 3
  s_add_u32 s13, s13, 1
  s_lshl_b32 s27, s26, 12
  s_add_u32 m0, s27, s83
  s_lshl_b32 s27, s26, 14
  s_add_u32 s27, s27, s82
  buffer_load_dwordx4 v250, s[60:63], s27 offen offset:0 lds
  buffer_load_dwordx4 v251, s[60:63], s27 offen offset:1024 lds
  buffer_load_dwordx4 v252, s[60:63], s27 offen offset:2048 lds
  buffer_load_dwordx4 v253, s[60:63], s27 offen offset:3072 lds
  s_branch L_du_26
L_de_27:
  v_mov_b32 v128, 0
  v_mov_b32 v129, 0
  v_mov_b32 v130, 0
  v_mov_b32 v131, 0
  v_mov_b32 v132, 0
  v_mov_b32 v133, 0
  v_mov_b32 v134, 0
  v_mov_b32 v135, 0
  v_mov_b32 v136, 0
  v_mov_b32 v137, 0
  v_mov_b32 v138, 0
  v_mov_b32 v139, 0
  v_mov_b32 v140, 0
  v_mov_b32 v141, 0
  v_mov_b32 v142, 0
  v_mov_b32 v143, 0
  v_mov_b32 v144, 0
  v_mov_b32 v145, 0
  v_mov_b32 v146, 0
  v_mov_b32 v147, 0
  v_mov_b32 v148, 0
  v_mov_b32 v149, 0
  v_mov_b32 v150, 0
  v_mov_b32 v151, 0
  v_mov_b32 v152, 0
  v_mov_b32 v153, 0
  v_mov_b32 v154, 0
  v_mov_b32 v155, 0
  v_mov_b32 v156, 0
  v_mov_b32 v157, 0
  v_mov_b32 v158, 0
  v_mov_b32 v159, 0
  v_mov_b32 v240, 0xf149f2ca
  v_mov_b32 v241, 0xf149f2ca
  s_branch L_p2done
L_fA:
  v_mov_b32 v5, v162
  s_nop 1
  v_max_u32_dpp v5, v5, v5 quad_perm:[1,0,3,2] row_mask:0xf bank_mask:0xf
  s_nop 1
  v_max_u32_dpp v5, v5, v5 quad_perm:[2,3,0,1] row_mask:0xf bank_mask:0xf
  v_cmp_eq_u32 vcc, v5, v162
  v_readfirstlane_b32 s9, v5
  s_ff1_i32_b32 s20, vcc_lo
  v_readlane_b32 s18, v160, s20
  v_readlane_b32 s19, v161, s20
  v_permlane16_swap_b32 v60, v64
  v_permlane16_swap_b32 v61, v65
  v_permlane16_swap_b32 v62, v66
  v_permlane16_swap_b32 v63, v67
  v_permlane16_swap_b32 v72, v76
  v_permlane16_swap_b32 v73, v77
  v_permlane16_swap_b32 v74, v78
  v_permlane16_swap_b32 v75, v79
  s_setprio 1
  s_cmp_eq_u32 s16, 0
  s_cbranch_scc1 L_fa0_29
  v_mfma_f32_32x32x16_bf16 v[160:175], v[56:59], v[88:91], 0
  v_mfma_f32_32x32x16_bf16 v[176:191], v[68:71], v[92:95], 0
  s_nop 10
  v_exp_f32 v160, v160
  v_exp_f32 v161, v161
  v_exp_f32 v162, v162
  buffer_load_dwordx4 v[8:11], v242, s[48:51], s90 offen sc1
  v_exp_f32 v163, v163
  v_exp_f32 v164, v164
  v_exp_f32 v165, v165
  v_exp_f32 v166, v166
  v_exp_f32 v167, v167
  buffer_load_dwordx4 v[20:23], v242, s[48:51], s91 offen sc1
  v_exp_f32 v168, v168
  v_exp_f32 v169, v169
  v_exp_f32 v170, v170
  v_exp_f32 v171, v171
  v_exp_f32 v172, v172
  buffer_load_dwordx4 v[32:35], v242, s[48:51], s92 offen sc1
  v_exp_f32 v173, v173
  v_exp_f32 v174, v174
  v_exp_f32 v175, v175
  v_cvt_pk_bf16_f32 v160, v160, v161
  v_cvt_pk_bf16_f32 v161, v162, v163
  buffer_load_dwordx4 v[44:47], v242, s[48:51], s93 offen sc1
  v_cvt_pk_bf16_f32 v162, v164, v165
  v_cvt_pk_bf16_f32 v163, v166, v167
  v_cvt_pk_bf16_f32 v164, v168, v169
  v_cvt_pk_bf16_f32 v165, v170, v171
  v_cvt_pk_bf16_f32 v166, v172, v173
  buffer_load_dwordx2 v[80:81], v244, s[48:51], s94 offen sc1
  v_cvt_pk_bf16_f32 v167, v174, v175
  v_bfi_b32 v160, v232, 0, v160
  v_bfi_b32 v161, v233, 0, v161
  v_bfi_b32 v162, v234, 0, v162
  v_bfi_b32 v163, v235, 0, v163
  buffer_load_dwordx2 v[82:83], v244, s[48:51], s95 offen sc1
  v_bfi_b32 v164, v236, 0, v164
  v_bfi_b32 v165, v237, 0, v165
  v_bfi_b32 v166, v238, 0, v166
  v_bfi_b32 v167, v239, 0, v167
  v_mfma_f32_32x32x16_bf16 v[192:207], v[56:59], v[92:95], 0
  v_exp_f32 v176, v176
  v_exp_f32 v177, v177
  v_exp_f32 v178, v178
  v_exp_f32 v179, v179
  v_exp_f32 v180, v180
  v_mfma_f32_32x32x16_bf16 v[128:143], v[60:63], v[160:163], 0
  v_exp_f32 v181, v181
  buffer_load_dwordx4 v[12:15], v243, s[48:51], s90 offen sc1
  v_exp_f32 v182, v182
  v_exp_f32 v183, v183
  v_exp_f32 v184, v184
  v_exp_f32 v185, v185
  v_mfma_f32_32x32x16_bf16 v[128:143], v[64:67], v[164:167], v[128:143]
  v_exp_f32 v186, v186
  v_exp_f32 v187, v187
  v_exp_f32 v188, v188
  v_exp_f32 v189, v189
  v_exp_f32 v190, v190
  v_exp_f32 v191, v191
  buffer_load_dwordx4 v[24:27], v243, s[48:51], s91 offen sc1
  v_cvt_pk_bf16_f32 v176, v176, v177
  v_cvt_pk_bf16_f32 v177, v178, v179
  v_cvt_pk_bf16_f32 v178, v180, v181
  v_cvt_pk_bf16_f32 v179, v182, v183
  v_cvt_pk_bf16_f32 v180, v184, v185
  v_cvt_pk_bf16_f32 v181, v186, v187
  v_cvt_pk_bf16_f32 v182, v188, v189
  v_cvt_pk_bf16_f32 v183, v190, v191
  v_bfi_b32 v176, v232, 0, v176
  v_bfi_b32 v177, v233, 0, v177
  buffer_load_dwordx4 v[36:39], v243, s[48:51], s92 offen sc1
  v_bfi_b32 v178, v234, 0, v178
  v_bfi_b32 v179, v235, 0, v179
  v_bfi_b32 v180, v236, 0, v180
  v_bfi_b32 v181, v237, 0, v181
  v_bfi_b32 v182, v238, 0, v182
  v_bfi_b32 v183, v239, 0, v183
  v_mfma_f32_32x32x16_bf16 v[144:159], v[72:75], v[176:179], 0
  v_exp_f32 v192, v192
  v_exp_f32 v193, v193
  v_exp_f32 v194, v194
  v_exp_f32 v195, v195
  v_exp_f32 v196, v196
  buffer_load_dwordx4 v[48:51], v243, s[48:51], s93 offen sc1
  v_mfma_f32_32x32x16_bf16 v[144:159], v[76:79], v[180:183], v[144:159]
  v_exp_f32 v197, v197
  v_exp_f32 v198, v198
  v_exp_f32 v199, v199
  v_exp_f32 v200, v200
  v_exp_f32 v201, v201
  v_exp_f32 v202, v202
  v_exp_f32 v203, v203
  v_exp_f32 v204, v204
  buffer_load_dwordx2 v[84:85], v244, s[48:51], s94 offen offset:2048 sc1
  v_exp_f32 v205, v205
  v_exp_f32 v206, v206
  v_exp_f32 v207, v207
  v_cvt_pk_bf16_f32 v192, v192, v193
  v_cvt_pk_bf16_f32 v193, v194, v195
  v_cvt_pk_bf16_f32 v194, v196, v197
  v_cvt_pk_bf16_f32 v195, v198, v199
  v_cvt_pk_bf16_f32 v196, v200, v201
  buffer_load_dwordx2 v[86:87], v244, s[48:51], s95 offen offset:2048 sc1
  v_cvt_pk_bf16_f32 v197, v202, v203
  v_cvt_pk_bf16_f32 v198, v204, v205
  v_cvt_pk_bf16_f32 v199, v206, v207
  v_mfma_f32_32x32x16_bf16 v[144:159], v[60:63], v[192:195], v[144:159]
  s_nop 0
  v_mfma_f32_32x32x16_bf16 v[144:159], v[64:67], v[196:199], v[144:159]
  s_waitcnt vmcnt(6)
  v_add3_u32 v2, v8, v9, v10
  v_add3_u32 v2, v2, v11, s7
  v_xor_b32 v2, v2, v80
  v_add3_u32 v3, v20, v21, v22
  v_add3_u32 v3, v3, v23, s7
  v_xor_b32 v3, v3, v81
  v_add3_u32 v4, v32, v33, v34
  v_add3_u32 v4, v4, v35, s7
  v_xor_b32 v4, v4, v82
  v_add3_u32 v5, v44, v45, v46
  v_add3_u32 v5, v5, v47, s7
  v_xor_b32 v5, v5, v83
  v_or_b32 v2, v2, v3
  v_or_b32 v4, v4, v5
  v_and_b32 v2, s16, v2
  v_and_or_b32 v2, v4, s17, v2
  v_cmp_ne_u32 vcc, 0, v2
  s_cbranch_vccz L_ok_31
L_rt_30:
  buffer_load_dwordx4 v[8:11], v242, s[48:51], s90 offen sc1
  buffer_load_dwordx4 v[20:23], v242, s[48:51], s91 offen sc1
  buffer_load_dwordx4 v[32:35], v242, s[48:51], s92 offen sc1
  buffer_load_dwordx4 v[44:47], v242, s[48:51], s93 offen sc1
  buffer_load_dwordx2 v[80:81], v244, s[48:51], s94 offen sc1
  buffer_load_dwordx2 v[82:83], v244, s[48:51], s95 offen sc1
  buffer_load_dwordx4 v[12:15], v243, s[48:51], s90 offen sc1
  buffer_load_dwordx4 v[24:27], v243, s[48:51], s91 offen sc1
  buffer_load_dwordx4 v[36:39], v243, s[48:51], s92 offen sc1
  buffer_load_dwordx4 v[48:51], v243, s[48:51], s93 offen sc1
  buffer_load_dwordx2 v[84:85], v244, s[48:51], s94 offen offset:2048 sc1
  buffer_load_dwordx2 v[86:87], v244, s[48:51], s95 offen offset:2048 sc1
  s_waitcnt vmcnt(0)
  v_add3_u32 v2, v8, v9, v10
  v_add3_u32 v2, v2, v11, s7
  v_xor_b32 v2, v2, v80
  v_add3_u32 v3, v20, v21, v22
  v_add3_u32 v3, v3, v23, s7
  v_xor_b32 v3, v3, v81
  v_add3_u32 v4, v32, v33, v34
  v_add3_u32 v4, v4, v35, s7
  v_xor_b32 v4, v4, v82
  v_add3_u32 v5, v44, v45, v46
  v_add3_u32 v5, v5, v47, s7
  v_xor_b32 v5, v5, v83
  v_or_b32 v2, v2, v3
  v_or_b32 v4, v4, v5
  v_and_b32 v2, s16, v2
  v_and_or_b32 v2, v4, s17, v2
  v_cmp_ne_u32 vcc, 0, v2
  s_add_u32 s88, s88, 1
  s_cmp_gt_u32 s88, 20000
  s_cbranch_scc1 L_end
  s_cbranch_vccnz L_rt_30
L_ok_31:
  s_cmp_eq_u32 s17, 0
  s_cbranch_scc1 L_fa1_28
  v_mfma_f32_32x32x16_bf16 v[160:175], v[8:11], v[88:91], 0
  v_mfma_f32_32x32x16_bf16 v[176:191], v[8:11], v[92:95], 0
  s_nop 10
  v_exp_f32 v160, v160
  v_exp_f32 v161, v161
  v_exp_f32 v162, v162
  v_exp_f32 v163, v163
  v_exp_f32 v164, v164
  v_exp_f32 v165, v165
  v_exp_f32 v166, v166
  v_exp_f32 v167, v167
  v_exp_f32 v168, v168
  v_exp_f32 v169, v169
  v_exp_f32 v170, v170
  v_exp_f32 v171, v171
  v_exp_f32 v172, v172
  v_exp_f32 v173, v173
  v_exp_f32 v174, v174
  v_exp_f32 v175, v175
  v_cvt_pk_bf16_f32 v160, v160, v161
  v_cvt_pk_bf16_f32 v161, v162, v163
  v_cvt_pk_bf16_f32 v162, v164, v165
  v_cvt_pk_bf16_f32 v163, v166, v167
  v_cvt_pk_bf16_f32 v164, v168, v169
  v_cvt_pk_bf16_f32 v165, v170, v171
  v_cvt_pk_bf16_f32 v166, v172, v173
  v_cvt_pk_bf16_f32 v167, v174, v175
  s_waitcnt vmcnt(0)
  v_add3_u32 v2, v12, v13, v14
  v_add3_u32 v2, v2, v15, s7
  v_xor_b32 v2, v2, v84
  v_add3_u32 v3, v24, v25, v26
  v_add3_u32 v3, v3, v27, s7
  v_xor_b32 v3, v3, v85
  v_add3_u32 v4, v36, v37, v38
  v_add3_u32 v4, v4, v39, s7
  v_xor_b32 v4, v4, v86
  v_add3_u32 v5, v48, v49, v50
  v_add3_u32 v5, v5, v51, s7
  v_xor_b32 v5, v5, v87
  v_or_b32 v2, v2, v3
  v_or_b32 v4, v4, v5
  v_and_b32 v2, s16, v2
  v_and_or_b32 v2, v4, s17, v2
  v_cmp_ne_u32 vcc, 0, v2
  s_cbranch_vccz L_ok_33
L_rt_32:
  buffer_load_dwordx4 v[12:15], v243, s[48:51], s90 offen sc1
  buffer_load_dwordx4 v[24:27], v243, s[48:51], s91 offen sc1
  buffer_load_dwordx4 v[36:39], v243, s[48:51], s92 offen sc1
  buffer_load_dwordx4 v[48:51], v243, s[48:51], s93 offen sc1
  buffer_load_dwordx2 v[84:85], v244, s[48:51], s94 offen offset:2048 sc1
  buffer_load_dwordx2 v[86:87], v244, s[48:51], s95 offen offset:2048 sc1
  s_waitcnt vmcnt(0)
  v_add3_u32 v2, v12, v13, v14
  v_add3_u32 v2, v2, v15, s7
  v_xor_b32 v2, v2, v84
  v_add3_u32 v3, v24, v25, v26
  v_add3_u32 v3, v3, v27, s7
  v_xor_b32 v3, v3, v85
  v_add3_u32 v4, v36, v37, v38
  v_add3_u32 v4, v4, v39, s7
  v_xor_b32 v4, v4, v86
  v_add3_u32 v5, v48, v49, v50
  v_add3_u32 v5, v5, v51, s7
  v_xor_b32 v5, v5, v87
  v_or_b32 v2, v2, v3
  v_or_b32 v4, v4, v5
  v_and_b32 v2, s16, v2
  v_and_or_b32 v2, v4, s17, v2
  v_cmp_ne_u32 vcc, 0, v2
  s_add_u32 s88, s88, 1
  s_cmp_gt_u32 s88, 20000
  s_cbranch_scc1 L_end
  s_cbranch_vccnz L_rt_32
L_ok_33:
  v_permlane16_swap_b32 v12, v16
  v_permlane16_swap_b32 v13, v17
  v_permlane16_swap_b32 v14, v18
  v_permlane16_swap_b32 v15, v19
  v_permlane16_swap_b32 v24, v28
  v_permlane16_swap_b32 v25, v29
  v_permlane16_swap_b32 v26, v30
  v_permlane16_swap_b32 v27, v31
  v_permlane16_swap_b32 v36, v40
  v_permlane16_swap_b32 v37, v41
  v_permlane16_swap_b32 v38, v42
  v_permlane16_swap_b32 v39, v43
  v_permlane16_swap_b32 v48, v52
  v_permlane16_swap_b32 v49, v53
  v_permlane16_swap_b32 v50, v54
  v_permlane16_swap_b32 v51, v55
  s_cmp_ge_u32 s85, 43
  s_cbranch_scc1 L_nwd_34
  s_lshl_b32 s37, s85, 15
  s_lshl_b32 s20, s14, 8
  s_add_u32 s37, s37, s20
  v_lshrrev_b32 v2, 4, v1
  v_and_b32 v3, 15, v1
  v_lshlrev_b32 v3, 4, v3
  v_lshl_add_u32 v2, v2, 10, v3
  buffer_load_dwordx4 v[96:99], v2, s[76:79], s37 offen nt
  s_add_u32 s37, s37, 4096
  buffer_load_dwordx4 v[100:103], v2, s[76:79], s37 offen nt
  s_add_u32 s37, s37, 4096
  buffer_load_dwordx4 v[104:107], v2, s[76:79], s37 offen nt
  s_add_u32 s37, s37, 4096
  buffer_load_dwordx4 v[108:111], v2, s[76:79], s37 offen nt
  s_add_u32 s37, s37, 4096
  buffer_load_dwordx4 v[112:115], v2, s[76:79], s37 offen nt
  s_add_u32 s37, s37, 4096
  buffer_load_dwordx4 v[116:119], v2, s[76:79], s37 offen nt
  s_add_u32 s37, s37, 4096
  buffer_load_dwordx4 v[120:123], v2, s[76:79], s37 offen nt
  s_add_u32 s37, s37, 4096
  buffer_load_dwordx4 v[124:127], v2, s[76:79], s37 offen nt
  s_add_u32 s37, s37, 4096
L_nwd_34:
  v_mfma_f32_32x32x16_bf16 v[192:207], v[20:23], v[88:91], 0
  v_exp_f32 v176, v176
  v_exp_f32 v177, v177
  v_exp_f32 v178, v178
  v_exp_f32 v179, v179
  s_and_b32 s26, s13, 3
  s_add_u32 s13, s13, 1
  s_lshl_b32 s27, s26, 12
  s_add_u32 m0, s27, s83
  s_lshl_b32 s27, s26, 14
  s_add_u32 s27, s27, s82
  buffer_load_dwordx4 v250, s[60:63], s27 offen offset:0 lds
  v_exp_f32 v180, v180
  v_mfma_f32_32x32x16_bf16 v[128:143], v[12:15], v[160:163], v[128:143]
  v_exp_f32 v181, v181
  v_exp_f32 v182, v182
  v_exp_f32 v183, v183
  v_exp_f32 v184, v184
  v_exp_f32 v185, v185
  buffer_load_dwordx4 v251, s[60:63], s27 offen offset:1024 lds
  v_mfma_f32_32x32x16_bf16 v[128:143], v[16:19], v[164:167], v[128:143]
  v_exp_f32 v186, v186
  v_exp_f32 v187, v187
  v_exp_f32 v188, v188
  v_exp_f32 v189, v189
  v_exp_f32 v190, v190
  v_exp_f32 v191, v191
  buffer_load_dwordx4 v252, s[60:63], s27 offen offset:2048 lds
  v_cvt_pk_bf16_f32 v176, v176, v177
  v_cvt_pk_bf16_f32 v177, v178, v179
  v_cvt_pk_bf16_f32 v178, v180, v181
  v_cvt_pk_bf16_f32 v179, v182, v183
  v_cvt_pk_bf16_f32 v180, v184, v185
  v_cvt_pk_bf16_f32 v181, v186, v187
  buffer_load_dwordx4 v253, s[60:63], s27 offen offset:3072 lds
  v_cvt_pk_bf16_f32 v182, v188, v189
  v_cvt_pk_bf16_f32 v183, v190, v191
  v_mfma_f32_32x32x16_bf16 v[160:175], v[20:23], v[92:95], 0
  v_exp_f32 v192, v192
  v_exp_f32 v193, v193
  v_exp_f32 v194, v194
  v_exp_f32 v195, v195
  v_exp_f32 v196, v196
  v_mfma_f32_32x32x16_bf16 v[144:159], v[12:15], v[176:179], v[144:159]
  v_exp_f32 v197, v197
  v_exp_f32 v198, v198
  v_exp_f32 v199, v199
  v_exp_f32 v200, v200
  v_exp_f32 v201, v201
  v_mfma_f32_32x32x16_bf16 v[144:159], v[16:19], v[180:183], v[144:159]
  v_exp_f32 v202, v202
  v_exp_f32 v203, v203
  v_exp_f32 v204, v204
  v_exp_f32 v205, v205
  v_exp_f32 v206, v206
  v_exp_f32 v207, v207
  v_cvt_pk_bf16_f32 v192, v192, v193
  v_cvt_pk_bf16_f32 v193, v194, v195
  v_cvt_pk_bf16_f32 v194, v196, v197
  v_cvt_pk_bf16_f32 v195, v198, v199
  v_cvt_pk_bf16_f32 v196, v200, v201
  v_cvt_pk_bf16_f32 v197, v202, v203
  v_cvt_pk_bf16_f32 v198, v204, v205
  v_cvt_pk_bf16_f32 v199, v206, v207
  v_mfma_f32_32x32x16_bf16 v[176:191], v[44:47], v[88:91], 0
  v_exp_f32 v160, v160
  v_exp_f32 v161, v161
  v_exp_f32 v162, v162
  v_exp_f32 v163, v163
  v_exp_f32 v164, v164
  v_mfma_f32_32x32x16_bf16 v[128:143], v[24:27], v[192:195], v[128:143]
  v_exp_f32 v165, v165
  v_exp_f32 v166, v166
  v_exp_f32 v167, v167
  v_exp_f32 v168, v168
  v_exp_f32 v169, v169
  v_mfma_f32_32x32x16_bf16 v[128:143], v[28:31], v[196:199], v[128:143]
  v_exp_f32 v170, v170
  v_exp_f32 v171, v171
  v_exp_f32 v172, v172
  v_exp_f32 v173, v173
  v_exp_f32 v174, v174
  v_exp_f32 v175, v175
  v_cvt_pk_bf16_f32 v160, v160, v161
  v_cvt_pk_bf16_f32 v161, v162, v163
  v_cvt_pk_bf16_f32 v162, v164, v165
  v_cvt_pk_bf16_f32 v163, v166, v167
  v_cvt_pk_bf16_f32 v164, v168, v169
  v_cvt_pk_bf16_f32 v165, v170, v171
  v_cvt_pk_bf16_f32 v166, v172, v173
  v_cvt_pk_bf16_f32 v167, v174, v175
  v_mfma_f32_32x32x16_bf16 v[192:207], v[32:35], v[88:91], 0
  v_exp_f32 v176, v176
  v_exp_f32 v177, v177
  v_exp_f32 v178, v178
  v_exp_f32 v179, v179
  v_exp_f32 v180, v180
  v_mfma_f32_32x32x16_bf16 v[144:159], v[24:27], v[160:163], v[144:159]
  v_exp_f32 v181, v181
  v_exp_f32 v182, v182
  v_exp_f32 v183, v183
  v_exp_f32 v184, v184
  v_exp_f32 v185, v185
  v_mfma_f32_32x32x16_bf16 v[144:159], v[28:31], v[164:167], v[144:159]
  v_exp_f32 v186, v186
  v_exp_f32 v187, v187
  v_exp_f32 v188, v188
  v_exp_f32 v189, v189
  v_exp_f32 v190, v190
  v_exp_f32 v191, v191
  v_cvt_pk_bf16_f32 v176, v176, v177
  v_cvt_pk_bf16_f32 v177, v178, v179
  v_cvt_pk_bf16_f32 v178, v180, v181
  v_cvt_pk_bf16_f32 v179, v182, v183
  v_cvt_pk_bf16_f32 v180, v184, v185
  v_cvt_pk_bf16_f32 v181, v186, v187
  v_cvt_pk_bf16_f32 v182, v188, v189
  v_cvt_pk_bf16_f32 v183, v190, v191
  s_cmp_ge_u32 s85, 43
  s_cbranch_scc1 L_ngp_35
  s_lshl_b32 s36, s85, 9
  s_add_u32 s36, s36, 262144
  buffer_load_dwordx4 v[208:211], v255, s[48:51], s36 offen sc1
  s_add_u32 s36, s36, 45056
  buffer_load_dwordx4 v[212:215], v255, s[48:51], s36 offen sc1
  s_add_u32 s36, s36, 45056
  buffer_load_dwordx4 v[216:219], v255, s[48:51], s36 offen sc1
  s_add_u32 s36, s36, 45056
  buffer_load_dwordx4 v[220:223], v255, s[48:51], s36 offen sc1
  s_add_u32 s36, s36, 45056
L_ngp_35:
  v_mfma_f32_32x32x16_bf16 v[160:175], v[44:47], v[92:95], 0
  v_exp_f32 v192, v192
  v_exp_f32 v193, v193
  v_exp_f32 v194, v194
  v_exp_f32 v195, v195
  v_exp_f32 v196, v196
  s_and_b32 s26, s13, 3
  s_add_u32 s13, s13, 1
  s_lshl_b32 s27, s26, 12
  s_add_u32 m0, s27, s83
  s_lshl_b32 s27, s26, 14
  s_add_u32 s27, s27, s82
  buffer_load_dwordx4 v250, s[60:63], s27 offen offset:0 lds
  v_mfma_f32_32x32x16_bf16 v[128:143], v[48:51], v[176:179], v[128:143]
  v_exp_f32 v197, v197
  v_exp_f32 v198, v198
  v_exp_f32 v199, v199
  v_exp_f32 v200, v200
  v_exp_f32 v201, v201
  v_mfma_f32_32x32x16_bf16 v[128:143], v[52:55], v[180:183], v[128:143]
  v_exp_f32 v202, v202
  v_exp_f32 v203, v203
  v_exp_f32 v204, v204
  buffer_load_dwordx4 v251, s[60:63], s27 offen offset:1024 lds
  v_exp_f32 v205, v205
  v_exp_f32 v206, v206
  v_exp_f32 v207, v207
  v_cvt_pk_bf16_f32 v192, v192, v193
  v_cvt_pk_bf16_f32 v193, v194, v195
  v_cvt_pk_bf16_f32 v194, v196, v197
  v_cvt_pk_bf16_f32 v195, v198, v199
  v_cvt_pk_bf16_f32 v196, v200, v201
  buffer_load_dwordx4 v252, s[60:63], s27 offen offset:2048 lds
  v_cvt_pk_bf16_f32 v197, v202, v203
  v_cvt_pk_bf16_f32 v198, v204, v205
  v_cvt_pk_bf16_f32 v199, v206, v207
  v_and_b32 v192, v192, v232
  v_and_b32 v193, v193, v233
  v_and_b32 v194, v194, v234
  v_and_b32 v195, v195, v235
  v_and_b32 v196, v196, v236
  buffer_load_dwordx4 v253, s[60:63], s27 offen offset:3072 lds
  v_and_b32 v197, v197, v237
  v_and_b32 v198, v198, v238
  v_and_b32 v199, v199, v239
  v_mfma_f32_32x32x16_bf16 v[128:143], v[36:39], v[192:195], v[128:143]
  v_exp_f32 v160, v160
  v_exp_f32 v161, v161
  v_exp_f32 v162, v162
  v_exp_f32 v163, v163
  v_exp_f32 v164, v164
  s_and_b32 s26, s13, 3
  s_add_u32 s13, s13, 1
  s_lshl_b32 s27, s26, 12
  s_add_u32 m0, s27, s83
  s_lshl_b32 s27, s26, 14
  s_add_u32 s27, s27, s82
  buffer_load_dwordx4 v250, s[60:63], s27 offen offset:0 lds
  v_mfma_f32_32x32x16_bf16 v[128:143], v[40:43], v[196:199], v[128:143]
  v_exp_f32 v165, v165
  v_exp_f32 v166, v166
  v_exp_f32 v167, v167
  v_exp_f32 v168, v168
  v_exp_f32 v169, v169
  v_exp_f32 v170, v170
  v_exp_f32 v171, v171
  v_exp_f32 v172, v172
  buffer_load_dwordx4 v251, s[60:63], s27 offen offset:1024 lds
  v_exp_f32 v173, v173
  v_exp_f32 v174, v174
  v_exp_f32 v175, v175
  v_cvt_pk_bf16_f32 v160, v160, v161
  v_cvt_pk_bf16_f32 v161, v162, v163
  v_cvt_pk_bf16_f32 v162, v164, v165
  v_cvt_pk_bf16_f32 v163, v166, v167
  v_cvt_pk_bf16_f32 v164, v168, v169
  buffer_load_dwordx4 v252, s[60:63], s27 offen offset:2048 lds
  v_cvt_pk_bf16_f32 v165, v170, v171
  v_cvt_pk_bf16_f32 v166, v172, v173
  v_cvt_pk_bf16_f32 v167, v174, v175
  v_and_b32 v160, v160, v232
  v_and_b32 v161, v161, v233
  v_and_b32 v162, v162, v234
  v_and_b32 v163, v163, v235
  v_and_b32 v164, v164, v236
  buffer_load_dwordx4 v253, s[60:63], s27 offen offset:3072 lds
  v_and_b32 v165, v165, v237
  v_and_b32 v166, v166, v238
  v_and_b32 v167, v167, v239
  v_mfma_f32_32x32x16_bf16 v[144:159], v[48:51], v[160:163], v[144:159]
  s_nop 0
  v_mfma_f32_32x32x16_bf16 v[144:159], v[52:55], v[164:167], v[144:159]
  s_branch L_fchk
L_fa1_28:
  v_mfma_f32_32x32x16_bf16 v[160:175], v[8:11], v[88:91], 0
  v_mfma_f32_32x32x16_bf16 v[176:191], v[8:11], v[92:95], 0
  s_nop 10
  v_exp_f32 v160, v160
  v_exp_f32 v161, v161
  v_exp_f32 v162, v162
  v_exp_f32 v163, v163
  v_exp_f32 v164, v164
  v_exp_f32 v165, v165
  v_exp_f32 v166, v166
  v_exp_f32 v167, v167
  v_exp_f32 v168, v168
  v_exp_f32 v169, v169
  v_exp_f32 v170, v170
  v_exp_f32 v171, v171
  v_exp_f32 v172, v172
  v_exp_f32 v173, v173
  v_exp_f32 v174, v174
  v_exp_f32 v175, v175
  v_cvt_pk_bf16_f32 v160, v160, v161
  v_cvt_pk_bf16_f32 v161, v162, v163
  v_cvt_pk_bf16_f32 v162, v164, v165
  v_cvt_pk_bf16_f32 v163, v166, v167
  v_cvt_pk_bf16_f32 v164, v168, v169
  v_cvt_pk_bf16_f32 v165, v170, v171
  v_cvt_pk_bf16_f32 v166, v172, v173
  v_cvt_pk_bf16_f32 v167, v174, v175
  s_waitcnt vmcnt(0)
  v_add3_u32 v2, v12, v13, v14
  v_add3_u32 v2, v2, v15, s7
  v_xor_b32 v2, v2, v84
  v_add3_u32 v3, v24, v25, v26
  v_add3_u32 v3, v3, v27, s7
  v_xor_b32 v3, v3, v85
  v_add3_u32 v4, v36, v37, v38
  v_add3_u32 v4, v4, v39, s7
  v_xor_b32 v4, v4, v86
  v_add3_u32 v5, v48, v49, v50
  v_add3_u32 v5, v5, v51, s7
  v_xor_b32 v5, v5, v87
  v_or_b32 v2, v2, v3
  v_or_b32 v4, v4, v5
  v_and_b32 v2, s16, v2
  v_and_or_b32 v2, v4, s17, v2
  v_cmp_ne_u32 vcc, 0, v2
  s_cbranch_vccz L_ok_37
L_rt_36:
  buffer_load_dwordx4 v[12:15], v243, s[48:51], s90 offen sc1
  buffer_load_dwordx4 v[24:27], v243, s[48:51], s91 offen sc1
  buffer_load_dwordx4 v[36:39], v243, s[48:51], s92 offen sc1
  buffer_load_dwordx4 v[48:51], v243, s[48:51], s93 offen sc1
  buffer_load_dwordx2 v[84:85], v244, s[48:51], s94 offen offset:2048 sc1
  buffer_load_dwordx2 v[86:87], v244, s[48:51], s95 offen offset:2048 sc1
  s_waitcnt vmcnt(0)
  v_add3_u32 v2, v12, v13, v14
  v_add3_u32 v2, v2, v15, s7
  v_xor_b32 v2, v2, v84
  v_add3_u32 v3, v24, v25, v26
  v_add3_u32 v3, v3, v27, s7
  v_xor_b32 v3, v3, v85
  v_add3_u32 v4, v36, v37, v38
  v_add3_u32 v4, v4, v39, s7
  v_xor_b32 v4, v4, v86
  v_add3_u32 v5, v48, v49, v50
  v_add3_u32 v5, v5, v51, s7
  v_xor_b32 v5, v5, v87
  v_or_b32 v2, v2, v3
  v_or_b32 v4, v4, v5
  v_and_b32 v2, s16, v2
  v_and_or_b32 v2, v4, s17, v2
  v_cmp_ne_u32 vcc, 0, v2
  s_add_u32 s88, s88, 1
  s_cmp_gt_u32 s88, 20000
  s_cbranch_scc1 L_end
  s_cbranch_vccnz L_rt_36
L_ok_37:
  v_permlane16_swap_b32 v12, v16
  v_permlane16_swap_b32 v13, v17
  v_permlane16_swap_b32 v14, v18
  v_permlane16_swap_b32 v15, v19
  v_permlane16_swap_b32 v24, v28
  v_permlane16_swap_b32 v25, v29
  v_permlane16_swap_b32 v26, v30
  v_permlane16_swap_b32 v27, v31
  v_permlane16_swap_b32 v36, v40
  v_permlane16_swap_b32 v37, v41
  v_permlane16_swap_b32 v38, v42
  v_permlane16_swap_b32 v39, v43
  v_permlane16_swap_b32 v48, v52
  v_permlane16_swap_b32 v49, v53
  v_permlane16_swap_b32 v50, v54
  v_permlane16_swap_b32 v51, v55
  s_cmp_ge_u32 s85, 43
  s_cbranch_scc1 L_nwd_38
  s_lshl_b32 s37, s85, 15
  s_lshl_b32 s20, s14, 8
  s_add_u32 s37, s37, s20
  v_lshrrev_b32 v2, 4, v1
  v_and_b32 v3, 15, v1
  v_lshlrev_b32 v3, 4, v3
  v_lshl_add_u32 v2, v2, 10, v3
  buffer_load_dwordx4 v[96:99], v2, s[76:79], s37 offen nt
  s_add_u32 s37, s37, 4096
  buffer_load_dwordx4 v[100:103], v2, s[76:79], s37 offen nt
  s_add_u32 s37, s37, 4096
  buffer_load_dwordx4 v[104:107], v2, s[76:79], s37 offen nt
  s_add_u32 s37, s37, 4096
  buffer_load_dwordx4 v[108:111], v2, s[76:79], s37 offen nt
  s_add_u32 s37, s37, 4096
  buffer_load_dwordx4 v[112:115], v2, s[76:79], s37 offen nt
  s_add_u32 s37, s37, 4096
  buffer_load_dwordx4 v[116:119], v2, s[76:79], s37 offen nt
  s_add_u32 s37, s37, 4096
  buffer_load_dwordx4 v[120:123], v2, s[76:79], s37 offen nt
  s_add_u32 s37, s37, 4096
  buffer_load_dwordx4 v[124:127], v2, s[76:79], s37 offen nt
  s_add_u32 s37, s37, 4096
L_nwd_38:
  v_mfma_f32_32x32x16_bf16 v[192:207], v[20:23], v[88:91], 0
  v_exp_f32 v176, v176
  v_exp_f32 v177, v177
  v_exp_f32 v178, v178
  v_exp_f32 v179, v179
  v_exp_f32 v180, v180
  v_mfma_f32_32x32x16_bf16 v[128:143], v[12:15], v[160:163], v[128:143]
  v_exp_f32 v181, v181
  v_exp_f32 v182, v182
  v_exp_f32 v183, v183
  v_exp_f32 v184, v184
  v_exp_f32 v185, v185
  v_mfma_f32_32x32x16_bf16 v[128:143], v[16:19], v[164:167], v[128:143]
  v_exp_f32 v186, v186
  v_exp_f32 v187, v187
  v_exp_f32 v188, v188
  v_exp_f32 v189, v189
  v_exp_f32 v190, v190
  v_exp_f32 v191, v191
  v_cvt_pk_bf16_f32 v176, v176, v177
  v_cvt_pk_bf16_f32 v177, v178, v179
  v_cvt_pk_bf16_f32 v178, v180, v181
  v_cvt_pk_bf16_f32 v179, v182, v183
  v_cvt_pk_bf16_f32 v180, v184, v185
  v_cvt_pk_bf16_f32 v181, v186, v187
  v_cvt_pk_bf16_f32 v182, v188, v189
  v_cvt_pk_bf16_f32 v183, v190, v191
  v_mfma_f32_32x32x16_bf16 v[160:175], v[20:23], v[92:95], 0
  v_exp_f32 v192, v192
  v_exp_f32 v193, v193
  v_exp_f32 v194, v194
  v_exp_f32 v195, v195
  v_exp_f32 v196, v196
  v_mfma_f32_32x32x16_bf16 v[144:159], v[12:15], v[176:179], v[144:159]
  v_exp_f32 v197, v197
  v_exp_f32 v198, v198
  v_exp_f32 v199, v199
  v_exp_f32 v200, v200
  v_exp_f32 v201, v201
  v_mfma_f32_32x32x16_bf16 v[144:159], v[16:19], v[180:183], v[144:159]
  v_exp_f32 v202, v202
  v_exp_f32 v203, v203
  v_exp_f32 v204, v204
  v_exp_f32 v205, v205
  v_exp_f32 v206, v206
  v_exp_f32 v207, v207
  v_cvt_pk_bf16_f32 v192, v192, v193
  v_cvt_pk_bf16_f32 v193, v194, v195
  v_cvt_pk_bf16_f32 v194, v196, v197
  v_cvt_pk_bf16_f32 v195, v198, v199
  v_cvt_pk_bf16_f32 v196, v200, v201
  v_cvt_pk_bf16_f32 v197, v202, v203
  v_cvt_pk_bf16_f32 v198, v204, v205
  v_cvt_pk_bf16_f32 v199, v206, v207
  v_mfma_f32_32x32x16_bf16 v[128:143], v[24:27], v[192:195], v[128:143]
  v_exp_f32 v160, v160
  v_exp_f32 v161, v161
  v_exp_f32 v162, v162
  v_exp_f32 v163, v163
  v_exp_f32 v164, v164
  v_mfma_f32_32x32x16_bf16 v[128:143], v[28:31], v[196:199], v[128:143]
  v_exp_f32 v165, v165
  v_exp_f32 v166, v166
  v_exp_f32 v167, v167
  v_exp_f32 v168, v168
  v_exp_f32 v169, v169
  v_exp_f32 v170, v170
  v_exp_f32 v171, v171
  v_exp_f32 v172, v172
  v_exp_f32 v173, v173
  v_exp_f32 v174, v174
  v_exp_f32 v175, v175
  v_cvt_pk_bf16_f32 v160, v160, v161
  v_cvt_pk_bf16_f32 v161, v162, v163
  v_cvt_pk_bf16_f32 v162, v164, v165
  v_cvt_pk_bf16_f32 v163, v166, v167
  v_cvt_pk_bf16_f32 v164, v168, v169
  v_cvt_pk_bf16_f32 v165, v170, v171
  v_cvt_pk_bf16_f32 v166, v172, v173
  v_cvt_pk_bf16_f32 v167, v174, v175
  v_mfma_f32_32x32x16_bf16 v[144:159], v[24:27], v[160:163], v[144:159]
  s_nop 0
  v_mfma_f32_32x32x16_bf16 v[144:159], v[28:31], v[164:167], v[144:159]
L_du_39:
  s_sub_u32 s20, s84, 2
  s_cmp_ge_u32 s13, s20
  s_cbranch_scc1 L_de_40
  s_and_b32 s26, s13, 3
  s_add_u32 s13, s13, 1
  s_lshl_b32 s27, s26, 12
  s_add_u32 m0, s27, s83
  s_lshl_b32 s27, s26, 14
  s_add_u32 s27, s27, s82
  buffer_load_dwordx4 v250, s[60:63], s27 offen offset:0 lds
  buffer_load_dwordx4 v251, s[60:63], s27 offen offset:1024 lds
  buffer_load_dwordx4 v252, s[60:63], s27 offen offset:2048 lds
  buffer_load_dwordx4 v253, s[60:63], s27 offen offset:3072 lds
  s_branch L_du_39
L_de_40:
  s_cmp_ge_u32 s85, 43
  s_cbranch_scc1 L_ngp_41
  s_lshl_b32 s36, s85, 9
  s_add_u32 s36, s36, 262144
  buffer_load_dwordx4 v[208:211], v255, s[48:51], s36 offen sc1
  s_add_u32 s36, s36, 45056
  buffer_load_dwordx4 v[212:215], v255, s[48:51], s36 offen sc1
  s_add_u32 s36, s36, 45056
  buffer_load_dwordx4 v[216:219], v255, s[48:51], s36 offen sc1
  s_add_u32 s36, s36, 45056
  buffer_load_dwordx4 v[220:223], v255, s[48:51], s36 offen sc1
  s_add_u32 s36, s36, 45056
  s_waitcnt vmcnt(0)
L_ngp_41:
  s_branch L_fchk
L_fa0_29:
  s_cmp_ge_u32 s85, 43
  s_cbranch_scc1 L_nwd_42
  s_lshl_b32 s37, s85, 15
  s_lshl_b32 s20, s14, 8
  s_add_u32 s37, s37, s20
  v_lshrrev_b32 v2, 4, v1
  v_and_b32 v3, 15, v1
  v_lshlrev_b32 v3, 4, v3
  v_lshl_add_u32 v2, v2, 10, v3
  buffer_load_dwordx4 v[96:99], v2, s[76:79], s37 offen nt
  s_add_u32 s37, s37, 4096
  buffer_load_dwordx4 v[100:103], v2, s[76:79], s37 offen nt
  s_add_u32 s37, s37, 4096
  buffer_load_dwordx4 v[104:107], v2, s[76:79], s37 offen nt
  s_add_u32 s37, s37, 4096
  buffer_load_dwordx4 v[108:111], v2, s[76:79], s37 offen nt
  s_add_u32 s37, s37, 4096
  buffer_load_dwordx4 v[112:115], v2, s[76:79], s37 offen nt
  s_add_u32 s37, s37, 4096
  buffer_load_dwordx4 v[116:119], v2, s[76:79], s37 offen nt
  s_add_u32 s37, s37, 4096
  buffer_load_dwordx4 v[120:123], v2, s[76:79], s37 offen nt
  s_add_u32 s37, s37, 4096
  buffer_load_dwordx4 v[124:127], v2, s[76:79], s37 offen nt
  s_add_u32 s37, s37, 4096
L_nwd_42:
  v_mfma_f32_32x32x16_bf16 v[160:175], v[56:59], v[88:91], 0
  v_mfma_f32_32x32x16_bf16 v[176:191], v[68:71], v[92:95], 0
  s_nop 10
  v_exp_f32 v160, v160
  v_exp_f32 v161, v161
  v_exp_f32 v162, v162
  v_exp_f32 v163, v163
  v_exp_f32 v164, v164
  v_exp_f32 v165, v165
  v_exp_f32 v166, v166
  v_exp_f32 v167, v167
  v_exp_f32 v168, v168
  v_exp_f32 v169, v169
  v_exp_f32 v170, v170
  v_exp_f32 v171, v171
  v_exp_f32 v172, v172
  v_exp_f32 v173, v173
  v_exp_f32 v174, v174
  v_exp_f32 v175, v175
  v_cvt_pk_bf16_f32 v160, v160, v161
  v_cvt_pk_bf16_f32 v161, v162, v163
  v_cvt_pk_bf16_f32 v162, v164, v165
  v_cvt_pk_bf16_f32 v163, v166, v167
  v_cvt_pk_bf16_f32 v164, v168, v169
  v_cvt_pk_bf16_f32 v165, v170, v171
  v_cvt_pk_bf16_f32 v166, v172, v173
  v_cvt_pk_bf16_f32 v167, v174, v175
  v_bfi_b32 v160, v232, 0, v160
  v_bfi_b32 v161, v233, 0, v161
  v_bfi_b32 v162, v234, 0, v162
  v_bfi_b32 v163, v235, 0, v163
  v_bfi_b32 v164, v236, 0, v164
  v_bfi_b32 v165, v237, 0, v165
  v_bfi_b32 v166, v238, 0, v166
  v_bfi_b32 v167, v239, 0, v167
  v_mfma_f32_32x32x16_bf16 v[192:207], v[56:59], v[92:95], 0
  v_exp_f32 v176, v176
  v_exp_f32 v177, v177
  v_exp_f32 v178, v178
  v_exp_f32 v179, v179
  v_exp_f32 v180, v180
  v_mfma_f32_32x32x16_bf16 v[128:143], v[60:63], v[160:163], 0
  v_exp_f32 v181, v181
  v_exp_f32 v182, v182
  v_exp_f32 v183, v183
  v_exp_f32 v184, v184
  v_exp_f32 v185, v185
  v_mfma_f32_32x32x16_bf16 v[128:143], v[64:67], v[164:167], v[128:143]
  v_exp_f32 v186, v186
  v_exp_f32 v187, v187
  v_exp_f32 v188, v188
  v_exp_f32 v189, v189
  v_exp_f32 v190, v190
  v_exp_f32 v191, v191
  v_cvt_pk_bf16_f32 v176, v176, v177
  v_cvt_pk_bf16_f32 v177, v178, v179
  v_cvt_pk_bf16_f32 v178, v180, v181
  v_cvt_pk_bf16_f32 v179, v182, v183
  v_cvt_pk_bf16_f32 v180, v184, v185
  v_cvt_pk_bf16_f32 v181, v186, v187
  v_cvt_pk_bf16_f32 v182, v188, v189
  v_cvt_pk_bf16_f32 v183, v190, v191
  v_bfi_b32 v176, v232, 0, v176
  v_bfi_b32 v177, v233, 0, v177
  v_bfi_b32 v178, v234, 0, v178
  v_bfi_b32 v179, v235, 0, v179
  v_bfi_b32 v180, v236, 0, v180
  v_bfi_b32 v181, v237, 0, v181
  v_bfi_b32 v182, v238, 0, v182
  v_bfi_b32 v183, v239, 0, v183
  v_mfma_f32_32x32x16_bf16 v[144:159], v[72:75], v[176:179], 0
  v_exp_f32 v192, v192
  v_exp_f32 v193, v193
  v_exp_f32 v194, v194
  v_exp_f32 v195, v195
  v_exp_f32 v196, v196
  v_mfma_f32_32x32x16_bf16 v[144:159], v[76:79], v[180:183], v[144:159]
  v_exp_f32 v197, v197
  v_exp_f32 v198, v198
  v_exp_f32 v199, v199
  v_exp_f32 v200, v200
  v_exp_f32 v201, v201
  v_exp_f32 v202, v202
  v_exp_f32 v203, v203
  v_exp_f32 v204, v204
  v_exp_f32 v205, v205
  v_exp_f32 v206, v206
  v_exp_f32 v207, v207
  v_cvt_pk_bf16_f32 v192, v192, v193
  v_cvt_pk_bf16_f32 v193, v194, v195
  v_cvt_pk_bf16_f32 v194, v196, v197
  v_cvt_pk_bf16_f32 v195, v198, v199
  v_cvt_pk_bf16_f32 v196, v200, v201
  v_cvt_pk_bf16_f32 v197, v202, v203
  v_cvt_pk_bf16_f32 v198, v204, v205
  v_cvt_pk_bf16_f32 v199, v206, v207
  v_mfma_f32_32x32x16_bf16 v[144:159], v[60:63], v[192:195], v[144:159]
  s_nop 0
  v_mfma_f32_32x32x16_bf16 v[144:159], v[64:67], v[196:199], v[144:159]
L_du_43:
  s_sub_u32 s20, s84, 1
  s_cmp_ge_u32 s13, s20
  s_cbranch_scc1 L_de_44
  s_and_b32 s26, s13, 3
  s_add_u32 s13, s13, 1
  s_lshl_b32 s27, s26, 12
  s_add_u32 m0, s27, s83
  s_lshl_b32 s27, s26, 14
  s_add_u32 s27, s27, s82
  buffer_load_dwordx4 v250, s[60:63], s27 offen offset:0 lds
  buffer_load_dwordx4 v251, s[60:63], s27 offen offset:1024 lds
  buffer_load_dwordx4 v252, s[60:63], s27 offen offset:2048 lds
  buffer_load_dwordx4 v253, s[60:63], s27 offen offset:3072 lds
  s_branch L_du_43
L_de_44:
  s_waitcnt vmcnt(0)
  s_cmp_ge_u32 s85, 43
  s_cbranch_scc1 L_ngp_45
  s_lshl_b32 s36, s85, 9
  s_add_u32 s36, s36, 262144
  buffer_load_dwordx4 v[208:211], v255, s[48:51], s36 offen sc1
  s_add_u32 s36, s36, 45056
  buffer_load_dwordx4 v[212:215], v255, s[48:51], s36 offen sc1
  s_add_u32 s36, s36, 45056
  buffer_load_dwordx4 v[216:219], v255, s[48:51], s36 offen sc1
  s_add_u32 s36, s36, 45056
  buffer_load_dwordx4 v[220:223], v255, s[48:51], s36 offen sc1
  s_add_u32 s36, s36, 45056
  s_waitcnt vmcnt(0)
L_ngp_45:
L_fchk:
  v_subrev_u32 v2, 0x2b800000, v136
  s_nop 9
  v_subrev_u32 v3, 0x2b800000, v152
  v_max_u32 v2, v2, v3
  v_cmp_le_u32 vcc, 0x28000000, v2
  s_cbranch_vccnz L_slow
L_p2done:
  s_cmp_ge_u32 s85, 43
  s_cbranch_scc1 L_dend
  v_lshrrev_b32 v3, 4, v1
  v_lshlrev_b32 v3, 6, v3
  v_lshlrev_b32 v2, 4, v1
  v_xor_b32 v24, v2, v3
  v_lshrrev_b32 v3, 5, v1
  v_bfe_u32 v4, v1, 2, 2
  v_lshlrev_b32 v5, 8, v4
  v_lshl_add_u32 v5, v3, 11, v5
  v_lshl_add_u32 v5, v4, 6, v5
  v_bfe_u32 v3, v1, 4, 1
  v_lshl_add_u32 v5, v3, 5, v5
  v_and_b32 v3, 3, v1
  v_lshl_add_u32 v5, v3, 3, v5
  s_lshl_b32 s38, s14, 12
  s_add_u32 s38, s38, 114688
  v_add_u32 v24, s38, v24
  v_add_u32 v25, s38, v5
  v_xor_b32 v26, 64, v25
  v_xor_b32 v27, 128, v25
  v_xor_b32 v28, 192, v25
  s_waitcnt vmcnt(12)
  ds_write_b128 v24, v[96:99] offset:0
  ds_write_b128 v24, v[100:103] offset:1024
  ds_write_b128 v24, v[104:107] offset:2048
  ds_write_b128 v24, v[108:111] offset:3072
  ds_read_b64_tr_b16 v[96:97], v25 offset:0
  ds_read_b64_tr_b16 v[98:99], v25 offset:1024
  ds_read_b64_tr_b16 v[100:101], v26 offset:0
  ds_read_b64_tr_b16 v[102:103], v26 offset:1024
  ds_read_b64_tr_b16 v[104:105], v27 offset:0
  ds_read_b64_tr_b16 v[106:107], v27 offset:1024
  ds_read_b64_tr_b16 v[108:109], v28 offset:0
  ds_read_b64_tr_b16 v[110:111], v28 offset:1024
  ds_write_b128 v24, v[112:115] offset:0
  ds_write_b128 v24, v[116:119] offset:1024
  ds_write_b128 v24, v[120:123] offset:2048
  ds_write_b128 v24, v[124:127] offset:3072
  ds_read_b64_tr_b16 v[112:113], v25 offset:0
  ds_read_b64_tr_b16 v[114:115], v25 offset:1024
  ds_read_b64_tr_b16 v[116:117], v26 offset:0
  ds_read_b64_tr_b16 v[118:119], v26 offset:1024
  ds_read_b64_tr_b16 v[120:121], v27 offset:0
  ds_read_b64_tr_b16 v[122:123], v27 offset:1024
  ds_read_b64_tr_b16 v[124:125], v28 offset:0
  ds_read_b64_tr_b16 v[126:127], v28 offset:1024
  s_waitcnt vmcnt(8)
  v_xor_b32 v2, s7, v210
  v_xor_b32 v3, s7, v214
  v_xor_b32 v4, s7, v218
  v_xor_b32 v5, s7, v222
  v_or3_b32 v2, v2, v3, v4
  v_or_b32 v2, v2, v5
  v_cmp_ne_u32 vcc, 0, v2
  s_cbranch_vccz L_ok_47
L_rt_46:
  s_lshl_b32 s36, s85, 9
  s_add_u32 s36, s36, 262144
  buffer_load_dwordx4 v[208:211], v255, s[48:51], s36 offen sc1
  s_add_u32 s36, s36, 45056
  buffer_load_dwordx4 v[212:215], v255, s[48:51], s36 offen sc1
  s_add_u32 s36, s36, 45056
  buffer_load_dwordx4 v[216:219], v255, s[48:51], s36 offen sc1
  s_add_u32 s36, s36, 45056
  buffer_load_dwordx4 v[220:223], v255, s[48:51], s36 offen sc1
  s_add_u32 s36, s36, 45056
  s_waitcnt vmcnt(0)
  v_xor_b32 v2, s7, v210
  v_xor_b32 v3, s7, v214
  v_xor_b32 v4, s7, v218
  v_xor_b32 v5, s7, v222
  v_or3_b32 v2, v2, v3, v4
  v_or_b32 v2, v2, v5
  v_cmp_ne_u32 vcc, 0, v2
  s_add_u32 s88, s88, 1
  s_cmp_gt_u32 s88, 20000
  s_cbranch_scc1 L_end
  s_cbranch_vccnz L_rt_46
L_ok_47:
  v_add_f32 v2, v208, v212
  v_add_f32 v3, v209, v213
  v_add_f32 v4, v216, v220
  v_add_f32 v5, v217, v221
  v_add_f32 v2, v2, v4
  v_add_f32 v3, v3, v5
  v_mov_b32 v4, v2
  v_mov_b32 v5, v3
  s_nop 0
  v_permlane32_swap_b32 v2, v4
  v_permlane32_swap_b32 v3, v5
  v_add_f32 v2, v2, v4
  v_add_f32 v3, v3, v5
  v_cvt_pk_bf16_f32 v2, v2, v2
  v_and_b32 v2, 0xffff0000, v2
  v_cvt_pk_bf16_f32 v3, v3, v3
  v_and_b32 v3, 0xffff0000, v3
  v_mul_f32 v4, 0xbfb8aa3b, v2
  v_exp_f32 v4, v4
  s_nop 0
  v_add_f32 v4, 1.0, v4
  v_rcp_f32 v4, v4
  s_nop 0
  v_mul_f32 v2, v2, v4
  v_cvt_pk_bf16_f32 v2, v2, v2
  v_and_b32 v2, 0xffff0000, v2
  v_mul_f32 v2, v2, v3
  v_cvt_pk_bf16_f32 v2, v2, v2
  v_and_b32 v3, 31, v1
  v_lshl_add_u32 v3, v3, 1, s38
  ds_write_b16 v3, v2
  v_lshrrev_b32 v3, 5, v1
  v_lshl_add_u32 v3, v3, 4, s38
  ds_read_b128 v[32:35], v3
  ds_read_b128 v[36:39], v3 offset:32
  s_lshl_b32 s20, s85, 12
  s_lshl_b32 s21, s14, 10
  s_add_u32 s20, s20, s21
  s_add_u32 s20, s20, 65536
  s_mov_b32 s22, 0
  s_mov_b32 s23, -1
  v_lshlrev_b32 v2, 4, v1
  v_mov_b32 v42, s7
  v_mov_b32 v43, s7
  s_waitcnt lgkmcnt(0)
  v_mfma_f32_32x32x16_bf16 v[160:175], v[32:35], v[96:99], 0
  v_mfma_f32_32x32x16_bf16 v[176:191], v[32:35], v[100:103], 0
  v_mfma_f32_32x32x16_bf16 v[192:207], v[32:35], v[104:107], 0
  v_mfma_f32_32x32x16_bf16 v[48:63], v[32:35], v[108:111], 0
  v_mfma_f32_32x32x16_bf16 v[160:175], v[36:39], v[112:115], v[160:175]
  v_mfma_f32_32x32x16_bf16 v[176:191], v[36:39], v[116:119], v[176:191]
  v_mfma_f32_32x32x16_bf16 v[192:207], v[36:39], v[120:123], v[192:207]
  v_mfma_f32_32x32x16_bf16 v[48:63], v[36:39], v[124:127], v[48:63]
  s_nop 10
  v_cndmask_b32_e64 v40, v160, v192, s[22:23]
  v_cndmask_b32_e64 v41, v176, v48, s[22:23]
  buffer_store_dwordx4 v[40:43], v2, s[48:51], s20 offen sc1
L_dend:
  s_cmp_lt_u32 s5, 4
  s_cbranch_scc1 L_npb0
L_du_48:
  s_sub_u32 s20, s84, 0
  s_cmp_ge_u32 s13, s20
  s_cbranch_scc1 L_de_49
  s_and_b32 s26, s13, 3
  s_add_u32 s13, s13, 1
  s_lshl_b32 s27, s26, 12
  s_add_u32 m0, s27, s83
  s_lshl_b32 s27, s26, 14
  s_add_u32 s27, s27, s82
  buffer_load_dwordx4 v250, s[60:63], s27 offen offset:0 lds
  buffer_load_dwordx4 v251, s[60:63], s27 offen offset:1024 lds
  buffer_load_dwordx4 v252, s[60:63], s27 offen offset:2048 lds
  buffer_load_dwordx4 v253, s[60:63], s27 offen offset:3072 lds
  s_branch L_du_48
L_de_49:
  s_sub_u32 s82, s82, 262144
  s_add_u32 s83, s83, 65536
  s_add_u32 s84, s84, 4
  s_add_u32 s13, s13, 0
L_npb0:
  v_xor_b32 v3, 0x4000, v246
  v_add_u32 v3, -49152, v3
  v_add_u32 v2, -49152, v246
  s_lshl_b32 s20, s3, 1
  s_add_u32 s20, s20, s15
  s_lshl_b32 s20, s20, 3
  s_add_u32 s20, s20, s4
  s_lshl_b32 s21, s20, 10
  s_add_u32 s21, s21, 8388608
  s_lshl_b32 s20, s20, 12
  s_add_u32 s20, s20, 6291456
  v_lshrrev_b32 v5, 2, v242
  v_mov_b32 v153, v241
  ds_write_b64 v3, v[152:153] offset:2048
  ds_write_b128 v3, v[144:147]
  ds_write_b128 v3, v[148:151] offset:1024
  s_waitcnt lgkmcnt(0)
  s_barrier
  ds_read_b64 v[168:169], v2 offset:2048
  ds_read_b128 v[160:163], v2
  ds_read_b128 v[164:167], v2 offset:1024
  s_waitcnt lgkmcnt(2)
  v_max_f32 v3, v240, v169
  v_sub_f32 v170, v240, v3
  v_sub_f32 v171, v169, v3
  v_exp_f32 v170, v170
  v_exp_f32 v171, v171
  v_mul_f32 v4, v170, v136
  v_fmac_f32 v4, v171, v168
  v_rcp_f32 v4, v4
  s_nop 0
  v_mul_f32 v170, v170, v4
  v_mul_f32 v171, v171, v4
  s_waitcnt lgkmcnt(0)
  v_pk_mul_f32 v[128:129], v[128:129], v[170:171] op_sel_hi:[1,0]
  v_pk_fma_f32 v[128:129], v[160:161], v[170:171], v[128:129] op_sel:[0,1,0]
  v_pk_mul_f32 v[130:131], v[130:131], v[170:171] op_sel_hi:[1,0]
  v_pk_fma_f32 v[130:131], v[162:163], v[170:171], v[130:131] op_sel:[0,1,0]
  v_pk_mul_f32 v[132:133], v[132:133], v[170:171] op_sel_hi:[1,0]
  v_pk_fma_f32 v[132:133], v[164:165], v[170:171], v[132:133] op_sel:[0,1,0]
  v_pk_mul_f32 v[134:135], v[134:135], v[170:171] op_sel_hi:[1,0]
  v_pk_fma_f32 v[134:135], v[166:167], v[170:171], v[134:135] op_sel:[0,1,0]
  v_cvt_pk_bf16_f32 v172, v128, v129
  v_cvt_pk_bf16_f32 v173, v130, v131
  v_cvt_pk_bf16_f32 v174, v132, v133
  v_cvt_pk_bf16_f32 v175, v134, v135
  buffer_store_dwordx4 v[172:175], v242, s[48:51], s20 offen sc1
  v_add3_u32 v4, v172, v173, v174
  v_add3_u32 v4, v4, v175, s7
  buffer_store_dword v4, v5, s[48:51], s21 offen sc1
  s_waitcnt vmcnt(2)
  s_barrier
  s_lshl_b32 s20, s81, 3
  s_add_u32 s20, s20, s5
  s_lshl_b32 s32, s20, 10
  s_add_u32 s32, s32, 8388608
  s_lshl_b32 s31, s20, 12
  s_add_u32 s31, s31, 6291456
  v_lshlrev_b32 v2, 4, v1
  v_lshlrev_b32 v243, 2, v1
  s_and_b32 s33, s9, 0x7ff
  s_sub_u32 s33, 2047, s33
  s_lshr_b32 s34, s33, 5
  s_cmp_lt_u32 s5, 4
  s_cbranch_scc1 L_nphb
L_du_51:
  s_sub_u32 s20, s84, 0
  s_cmp_ge_u32 s13, s20
  s_cbranch_scc1 L_de_52
  s_and_b32 s26, s13, 3
  s_add_u32 s13, s13, 1
  s_lshl_b32 s27, s26, 12
  s_add_u32 m0, s27, s83
  s_lshl_b32 s27, s26, 14
  s_add_u32 s27, s27, s82
  buffer_load_dwordx4 v250, s[60:63], s27 offen offset:0 lds
  buffer_load_dwordx4 v251, s[60:63], s27 offen offset:1024 lds
  buffer_load_dwordx4 v252, s[60:63], s27 offen offset:2048 lds
  buffer_load_dwordx4 v253, s[60:63], s27 offen offset:3072 lds
  s_branch L_du_51
L_de_52:
L_nphb:
  v_lshlrev_b32 v2, 4, v1
  s_cmp_ge_u32 s5, 4
  s_cbranch_scc1 L_p3l_50w
  v_permlane32_swap_b32 v80, v82
  v_permlane32_swap_b32 v81, v83
  v_permlane32_swap_b32 v84, v86
  v_permlane32_swap_b32 v85, v87
  v_lshlrev_b32 v160, 16, v80
  v_and_b32 v161, 0xffff0000, v80
  v_pk_add_f32 v[144:145], v[160:161], v[248:249] op_sel_hi:[1,0] neg_lo:[0,1] neg_hi:[0,1]
  v_cvt_pk_bf16_f32 v146, v144, v145
  v_lshlrev_b32 v144, 16, v146
  v_and_b32 v145, 0xffff0000, v146
  v_pk_mul_f32 v[144:145], v[144:145], v[248:249] op_sel:[0,1]
  v_cvt_pk_bf16_f32 v146, v144, v145
  v_lshlrev_b32 v144, 16, v146
  v_and_b32 v145, 0xffff0000, v146
  v_pk_add_f32 v[160:161], v[160:161], v[144:145]
  v_lshlrev_b32 v162, 16, v81
  v_and_b32 v163, 0xffff0000, v81
  v_pk_add_f32 v[144:145], v[162:163], v[248:249] op_sel_hi:[1,0] neg_lo:[0,1] neg_hi:[0,1]
  v_cvt_pk_bf16_f32 v146, v144, v145
  v_lshlrev_b32 v144, 16, v146
  v_and_b32 v145, 0xffff0000, v146
  v_pk_mul_f32 v[144:145], v[144:145], v[248:249] op_sel:[0,1]
  v_cvt_pk_bf16_f32 v146, v144, v145
  v_lshlrev_b32 v144, 16, v146
  v_and_b32 v145, 0xffff0000, v146
  v_pk_add_f32 v[162:163], v[162:163], v[144:145]
  v_lshlrev_b32 v164, 16, v82
  v_and_b32 v165, 0xffff0000, v82
  v_pk_add_f32 v[144:145], v[164:165], v[248:249] op_sel_hi:[1,0] neg_lo:[0,1] neg_hi:[0,1]
  v_cvt_pk_bf16_f32 v146, v144, v145
  v_lshlrev_b32 v144, 16, v146
  v_and_b32 v145, 0xffff0000, v146
  v_pk_mul_f32 v[144:145], v[144:145], v[248:249] op_sel:[0,1]
  v_cvt_pk_bf16_f32 v146, v144, v145
  v_lshlrev_b32 v144, 16, v146
  v_and_b32 v145, 0xffff0000, v146
  v_pk_add_f32 v[164:165], v[164:165], v[144:145]
  v_lshlrev_b32 v166, 16, v83
  v_and_b32 v167, 0xffff0000, v83
  v_pk_add_f32 v[144:145], v[166:167], v[248:249] op_sel_hi:[1,0] neg_lo:[0,1] neg_hi:[0,1]
  v_cvt_pk_bf16_f32 v146, v144, v145
  v_lshlrev_b32 v144, 16, v146
  v_and_b32 v145, 0xffff0000, v146
  v_pk_mul_f32 v[144:145], v[144:145], v[248:249] op_sel:[0,1]
  v_cvt_pk_bf16_f32 v146, v144, v145
  v_lshlrev_b32 v144, 16, v146
  v_and_b32 v145, 0xffff0000, v146
  v_pk_add_f32 v[166:167], v[166:167], v[144:145]
  v_lshlrev_b32 v168, 16, v84
  v_and_b32 v169, 0xffff0000, v84
  v_pk_add_f32 v[144:145], v[168:169], v[248:249] op_sel_hi:[1,0] neg_lo:[0,1] neg_hi:[0,1]
  v_cvt_pk_bf16_f32 v146, v144, v145
  v_lshlrev_b32 v144, 16, v146
  v_and_b32 v145, 0xffff0000, v146
  v_pk_mul_f32 v[144:145], v[144:145], v[248:249] op_sel:[0,1]
  v_cvt_pk_bf16_f32 v146, v144, v145
  v_lshlrev_b32 v144, 16, v146
  v_and_b32 v145, 0xffff0000, v146
  v_pk_add_f32 v[168:169], v[168:169], v[144:145]
  v_lshlrev_b32 v170, 16, v85
  v_and_b32 v171, 0xffff0000, v85
  v_pk_add_f32 v[144:145], v[170:171], v[248:249] op_sel_hi:[1,0] neg_lo:[0,1] neg_hi:[0,1]
  v_cvt_pk_bf16_f32 v146, v144, v145
  v_lshlrev_b32 v144, 16, v146
  v_and_b32 v145, 0xffff0000, v146
  v_pk_mul_f32 v[144:145], v[144:145], v[248:249] op_sel:[0,1]
  v_cvt_pk_bf16_f32 v146, v144, v145
  v_lshlrev_b32 v144, 16, v146
  v_and_b32 v145, 0xffff0000, v146
  v_pk_add_f32 v[170:171], v[170:171], v[144:145]
  v_lshlrev_b32 v172, 16, v86
  v_and_b32 v173, 0xffff0000, v86
  v_pk_add_f32 v[144:145], v[172:173], v[248:249] op_sel_hi:[1,0] neg_lo:[0,1] neg_hi:[0,1]
  v_cvt_pk_bf16_f32 v146, v144, v145
  v_lshlrev_b32 v144, 16, v146
  v_and_b32 v145, 0xffff0000, v146
  v_pk_mul_f32 v[144:145], v[144:145], v[248:249] op_sel:[0,1]
  v_cvt_pk_bf16_f32 v146, v144, v145
  v_lshlrev_b32 v144, 16, v146
  v_and_b32 v145, 0xffff0000, v146
  v_pk_add_f32 v[172:173], v[172:173], v[144:145]
  v_lshlrev_b32 v174, 16, v87
  v_and_b32 v175, 0xffff0000, v87
  v_pk_add_f32 v[144:145], v[174:175], v[248:249] op_sel_hi:[1,0] neg_lo:[0,1] neg_hi:[0,1]
  v_cvt_pk_bf16_f32 v146, v144, v145
  v_lshlrev_b32 v144, 16, v146
  v_and_b32 v145, 0xffff0000, v146
  v_pk_mul_f32 v[144:145], v[144:145], v[248:249] op_sel:[0,1]
  v_cvt_pk_bf16_f32 v146, v144, v145
  v_lshlrev_b32 v144, 16, v146
  v_and_b32 v145, 0xffff0000, v146
  v_pk_add_f32 v[174:175], v[174:175], v[144:145]
  v_lshlrev_b32 v2, 4, v1
  v_lshrrev_b32 v4, 5, v1
  v_bfe_u32 v3, v1, 2, 2
  v_lshl_add_u32 v5, v4, 2, v3
  v_lshlrev_b32 v5, 8, v5
  v_xor_b32 v3, s5, v3
  v_lshl_add_u32 v5, v3, 6, v5
  v_bfe_u32 v3, v1, 4, 1
  v_lshl_add_u32 v5, v3, 5, v5
  v_and_b32 v3, 3, v1
  v_lshl_add_u32 v5, v3, 3, v5
  v_add_u32 v3, 65536, v5
  ds_read_b64_tr_b16 v[72:73], v5 offset:0
  ds_read_b64_tr_b16 v[74:75], v5 offset:2048
  ds_read_b64_tr_b16 v[76:77], v5 offset:4096
  ds_read_b64_tr_b16 v[78:79], v5 offset:6144
  ds_read_b64_tr_b16 v[80:81], v5 offset:8192
  ds_read_b64_tr_b16 v[82:83], v5 offset:10240
  ds_read_b64_tr_b16 v[84:85], v5 offset:12288
  ds_read_b64_tr_b16 v[86:87], v5 offset:14336
  ds_read_b64_tr_b16 v[88:89], v5 offset:16384
  ds_read_b64_tr_b16 v[90:91], v5 offset:18432
  ds_read_b64_tr_b16 v[92:93], v5 offset:20480
  ds_read_b64_tr_b16 v[94:95], v5 offset:22528
  ds_read_b64_tr_b16 v[96:97], v5 offset:24576
  ds_read_b64_tr_b16 v[98:99], v5 offset:26624
  ds_read_b64_tr_b16 v[100:101], v5 offset:28672
  ds_read_b64_tr_b16 v[102:103], v5 offset:30720
  ds_read_b64_tr_b16 v[104:105], v5 offset:32768
  ds_read_b64_tr_b16 v[106:107], v5 offset:34816
  ds_read_b64_tr_b16 v[108:109], v5 offset:36864
  ds_read_b64_tr_b16 v[110:111], v5 offset:38912
  ds_read_b64_tr_b16 v[112:113], v5 offset:40960
  ds_read_b64_tr_b16 v[114:115], v5 offset:43008
  ds_read_b64_tr_b16 v[116:117], v5 offset:45056
  ds_read_b64_tr_b16 v[118:119], v5 offset:47104
  ds_read_b64_tr_b16 v[120:121], v5 offset:49152
  ds_read_b64_tr_b16 v[122:123], v5 offset:51200
  ds_read_b64_tr_b16 v[124:125], v5 offset:53248
  ds_read_b64_tr_b16 v[126:127], v5 offset:55296
  ds_read_b64_tr_b16 v[128:129], v5 offset:57344
  ds_read_b64_tr_b16 v[130:131], v5 offset:59392
  ds_read_b64_tr_b16 v[132:133], v5 offset:61440
  ds_read_b64_tr_b16 v[134:135], v5 offset:63488
  s_waitcnt vmcnt(0)
  s_branch L_p3l_50
L_p3l_50w:
  s_waitcnt vmcnt(16)
  buffer_load_dwordx4 v[208:211], v2, s[48:51], s31 offen offset:0 sc1
  buffer_load_dwordx4 v[212:215], v2, s[48:51], s31 offen offset:1024 sc1
  buffer_load_dwordx4 v[216:219], v2, s[48:51], s31 offen offset:2048 sc1
  buffer_load_dwordx4 v[220:223], v2, s[48:51], s31 offen offset:3072 sc1
  buffer_load_dword v224, v243, s[48:51], s32 offen offset:0 sc1
  buffer_load_dword v225, v243, s[48:51], s32 offen offset:256 sc1
  buffer_load_dword v226, v243, s[48:51], s32 offen offset:512 sc1
  buffer_load_dword v227, v243, s[48:51], s32 offen offset:768 sc1
  s_waitcnt vmcnt(0)
  s_branch L_p3l_50y
L_p3l_50:
  buffer_load_dwordx4 v[208:211], v2, s[48:51], s31 offen offset:0 sc1
  buffer_load_dwordx4 v[212:215], v2, s[48:51], s31 offen offset:1024 sc1
  buffer_load_dwordx4 v[216:219], v2, s[48:51], s31 offen offset:2048 sc1
  buffer_load_dwordx4 v[220:223], v2, s[48:51], s31 offen offset:3072 sc1
  buffer_load_dword v224, v243, s[48:51], s32 offen offset:0 sc1
  buffer_load_dword v225, v243, s[48:51], s32 offen offset:256 sc1
  buffer_load_dword v226, v243, s[48:51], s32 offen offset:512 sc1
  buffer_load_dword v227, v243, s[48:51], s32 offen offset:768 sc1
  s_waitcnt vmcnt(0)
L_p3l_50y:
  v_add3_u32 v228, v208, v209, v210
  v_add3_u32 v228, v228, v211, s7
  v_xor_b32 v228, v228, v224
  v_add3_u32 v229, v212, v213, v214
  v_add3_u32 v229, v229, v215, s7
  v_xor_b32 v229, v229, v225
  v_add3_u32 v230, v216, v217, v218
  v_add3_u32 v230, v230, v219, s7
  v_xor_b32 v230, v230, v226
  v_add3_u32 v231, v220, v221, v222
  v_add3_u32 v231, v231, v223, s7
  v_xor_b32 v231, v231, v227
  v_or3_b32 v228, v228, v229, v230
  v_or_b32 v228, v228, v231
  v_cmp_ne_u32 vcc, 0, v228
  s_add_u32 s88, s88, 1
  s_cmp_gt_u32 s88, 20000
  s_cbranch_scc1 L_end
  s_cbranch_vccnz L_p3l_50
  ds_write_b128 v246, v[208:211] offset:0
  ds_write_b128 v246, v[212:215] offset:1024
  ds_write_b128 v246, v[216:219] offset:2048
  ds_write_b128 v246, v[220:223] offset:3072
  s_cmp_lg_u32 s34, s81
  s_cbranch_scc1 L_nyl
  s_cmp_lt_u32 s5, 4
  s_cbranch_scc1 L_nyl
  s_and_b32 s20, s4, 3
  s_lshl_b32 s20, s20, 10
  s_add_u32 s20, s20, 65536
  s_add_u32 s21, s20, 172032
  s_mul_i32 s22, s14, 45056
  s_add_u32 s20, s20, s22
  buffer_load_dwordx4 v[8:11], v2, s[48:51], s20 offen sc1
  s_add_u32 s20, s20, 4096
  buffer_load_dwordx4 v[12:15], v2, s[48:51], s20 offen sc1
  s_add_u32 s20, s20, 4096
  buffer_load_dwordx4 v[16:19], v2, s[48:51], s20 offen sc1
  s_add_u32 s20, s20, 4096
  buffer_load_dwordx4 v[20:23], v2, s[48:51], s20 offen sc1
  s_add_u32 s20, s20, 4096
  buffer_load_dwordx4 v[24:27], v2, s[48:51], s20 offen sc1
  s_add_u32 s20, s20, 4096
  buffer_load_dwordx4 v[28:31], v2, s[48:51], s20 offen sc1
  s_add_u32 s20, s20, 4096
  buffer_load_dwordx4 v[32:35], v2, s[48:51], s20 offen sc1
  s_add_u32 s20, s20, 4096
  buffer_load_dwordx4 v[36:39], v2, s[48:51], s20 offen sc1
  s_add_u32 s20, s20, 4096
  buffer_load_dwordx4 v[40:43], v2, s[48:51], s20 offen sc1
  s_add_u32 s20, s20, 4096
  buffer_load_dwordx4 v[44:47], v2, s[48:51], s20 offen sc1
  s_add_u32 s20, s20, 4096
  s_min_u32 s20, s20, s21
  buffer_load_dwordx4 v[48:51], v2, s[48:51], s20 offen sc1
  s_add_u32 s20, s20, 4096
L_nyl:
  s_waitcnt lgkmcnt(0)
  s_barrier
  s_cmp_ge_u32 s5, 4
  s_cbranch_scc1 L_p3help
  v_add_u32 v2, 131072, v2
  ds_read_b128 v[176:179], v2 offset:16384
  ds_read_b128 v[180:183], v2 offset:17408
  ds_read_b128 v[184:187], v2 offset:18432
  ds_read_b128 v[188:191], v2 offset:19456
  ds_read_b128 v[192:195], v2 offset:20480
  ds_read_b128 v[196:199], v2 offset:21504
  s_waitcnt lgkmcnt(5)
  v_mfma_f32_32x32x16_bf16 v[160:175], v[72:75], v[176:179], v[160:175]
  ds_read_b64_tr_b16 v[8:9], v3 offset:0
  ds_read_b64_tr_b16 v[10:11], v3 offset:2048
  ds_read_b128 v[200:203], v2 offset:22528
  s_waitcnt lgkmcnt(7)
  v_mfma_f32_32x32x16_bf16 v[160:175], v[76:79], v[180:183], v[160:175]
  ds_read_b64_tr_b16 v[12:13], v3 offset:4096
  ds_read_b64_tr_b16 v[14:15], v3 offset:6144
  ds_read_b128 v[204:207], v2 offset:23552
  s_waitcnt lgkmcnt(9)
  v_mfma_f32_32x32x16_bf16 v[160:175], v[80:83], v[184:187], v[160:175]
  ds_read_b64_tr_b16 v[16:17], v3 offset:8192
  ds_read_b64_tr_b16 v[18:19], v3 offset:10240
  ds_read_b128 v[176:179], v2 offset:24576
  s_waitcnt lgkmcnt(11)
  v_mfma_f32_32x32x16_bf16 v[160:175], v[84:87], v[188:191], v[160:175]
  ds_read_b64_tr_b16 v[20:21], v3 offset:12288
  ds_read_b64_tr_b16 v[22:23], v3 offset:14336
  ds_read_b128 v[180:183], v2 offset:25600
  s_waitcnt lgkmcnt(13)
  v_mfma_f32_32x32x16_bf16 v[160:175], v[88:91], v[192:195], v[160:175]
  ds_read_b64_tr_b16 v[24:25], v3 offset:16384
  ds_read_b64_tr_b16 v[26:27], v3 offset:18432
  ds_read_b128 v[184:187], v2 offset:26624
  s_waitcnt lgkmcnt(15)
  v_mfma_f32_32x32x16_bf16 v[160:175], v[92:95], v[196:199], v[160:175]
  ds_read_b64_tr_b16 v[28:29], v3 offset:20480
  ds_read_b64_tr_b16 v[30:31], v3 offset:22528
  ds_read_b128 v[188:191], v2 offset:27648
  s_waitcnt lgkmcnt(15)
  v_mfma_f32_32x32x16_bf16 v[160:175], v[96:99], v[200:203], v[160:175]
  ds_read_b64_tr_b16 v[32:33], v3 offset:24576
  ds_read_b64_tr_b16 v[34:35], v3 offset:26624
  ds_read_b128 v[192:195], v2 offset:28672
  s_waitcnt lgkmcnt(15)
  v_mfma_f32_32x32x16_bf16 v[160:175], v[100:103], v[204:207], v[160:175]
  ds_read_b64_tr_b16 v[36:37], v3 offset:28672
  ds_read_b64_tr_b16 v[38:39], v3 offset:30720
  ds_read_b128 v[196:199], v2 offset:29696
  s_waitcnt lgkmcnt(15)
  v_mfma_f32_32x32x16_bf16 v[160:175], v[104:107], v[176:179], v[160:175]
  ds_read_b64_tr_b16 v[40:41], v3 offset:32768
  ds_read_b64_tr_b16 v[42:43], v3 offset:34816
  ds_read_b128 v[200:203], v2 offset:30720
  s_waitcnt lgkmcnt(15)
  v_mfma_f32_32x32x16_bf16 v[160:175], v[108:111], v[180:183], v[160:175]
  ds_read_b64_tr_b16 v[44:45], v3 offset:36864
  ds_read_b64_tr_b16 v[46:47], v3 offset:38912
  ds_read_b128 v[204:207], v2 offset:31744
  s_waitcnt lgkmcnt(15)
  v_mfma_f32_32x32x16_bf16 v[160:175], v[112:115], v[184:187], v[160:175]
  ds_read_b64_tr_b16 v[48:49], v3 offset:40960
  ds_read_b64_tr_b16 v[50:51], v3 offset:43008
  ds_read_b128 v[176:179], v2 offset:0
  s_waitcnt lgkmcnt(15)
  v_mfma_f32_32x32x16_bf16 v[160:175], v[116:119], v[188:191], v[160:175]
  ds_read_b64_tr_b16 v[52:53], v3 offset:45056
  ds_read_b64_tr_b16 v[54:55], v3 offset:47104
  ds_read_b128 v[180:183], v2 offset:1024
  s_waitcnt lgkmcnt(15)
  v_mfma_f32_32x32x16_bf16 v[160:175], v[120:123], v[192:195], v[160:175]
  ds_read_b64_tr_b16 v[56:57], v3 offset:49152
  ds_read_b64_tr_b16 v[58:59], v3 offset:51200
  ds_read_b128 v[184:187], v2 offset:2048
  s_waitcnt lgkmcnt(15)
  v_mfma_f32_32x32x16_bf16 v[160:175], v[124:127], v[196:199], v[160:175]
  ds_read_b64_tr_b16 v[60:61], v3 offset:53248
  ds_read_b64_tr_b16 v[62:63], v3 offset:55296
  ds_read_b128 v[188:191], v2 offset:3072
  s_waitcnt lgkmcnt(15)
  v_mfma_f32_32x32x16_bf16 v[160:175], v[128:131], v[200:203], v[160:175]
  ds_read_b64_tr_b16 v[64:65], v3 offset:57344
  ds_read_b64_tr_b16 v[66:67], v3 offset:59392
  ds_read_b128 v[192:195], v2 offset:4096
  s_waitcnt lgkmcnt(15)
  v_mfma_f32_32x32x16_bf16 v[160:175], v[132:135], v[204:207], v[160:175]
  ds_read_b64_tr_b16 v[68:69], v3 offset:61440
  ds_read_b64_tr_b16 v[70:71], v3 offset:63488
  ds_read_b128 v[196:199], v2 offset:5120
  s_waitcnt lgkmcnt(15)
  v_mfma_f32_32x32x16_bf16 v[160:175], v[8:11], v[176:179], v[160:175]
  ds_read_b128 v[200:203], v2 offset:6144
  s_waitcnt lgkmcnt(13)
  v_mfma_f32_32x32x16_bf16 v[160:175], v[12:15], v[180:183], v[160:175]
  ds_read_b128 v[204:207], v2 offset:7168
  s_waitcnt lgkmcnt(11)
  v_mfma_f32_32x32x16_bf16 v[160:175], v[16:19], v[184:187], v[160:175]
  ds_read_b128 v[176:179], v2 offset:8192
  s_waitcnt lgkmcnt(9)
  v_mfma_f32_32x32x16_bf16 v[160:175], v[20:23], v[188:191], v[160:175]
  ds_read_b128 v[180:183], v2 offset:9216
  s_waitcnt lgkmcnt(7)
  v_mfma_f32_32x32x16_bf16 v[160:175], v[24:27], v[192:195], v[160:175]
  ds_read_b128 v[184:187], v2 offset:10240
  s_waitcnt lgkmcnt(5)
  v_mfma_f32_32x32x16_bf16 v[160:175], v[28:31], v[196:199], v[160:175]
  ds_read_b128 v[188:191], v2 offset:11264
  s_waitcnt lgkmcnt(5)
  v_mfma_f32_32x32x16_bf16 v[160:175], v[32:35], v[200:203], v[160:175]
  ds_read_b128 v[192:195], v2 offset:12288
  s_waitcnt lgkmcnt(5)
  v_mfma_f32_32x32x16_bf16 v[160:175], v[36:39], v[204:207], v[160:175]
  ds_read_b128 v[196:199], v2 offset:13312
  s_waitcnt lgkmcnt(5)
  v_mfma_f32_32x32x16_bf16 v[160:175], v[40:43], v[176:179], v[160:175]
  ds_read_b128 v[200:203], v2 offset:14336
  s_waitcnt lgkmcnt(5)
  v_mfma_f32_32x32x16_bf16 v[160:175], v[44:47], v[180:183], v[160:175]
  ds_read_b128 v[204:207], v2 offset:15360
  s_waitcnt lgkmcnt(5)
  v_mfma_f32_32x32x16_bf16 v[160:175], v[48:51], v[184:187], v[160:175]
  s_waitcnt lgkmcnt(4)
  v_mfma_f32_32x32x16_bf16 v[160:175], v[52:55], v[188:191], v[160:175]
  s_cmp_lg_u32 s34, s81
  s_cbranch_scc1 L_nzb
  s_barrier
L_nzb:
  s_waitcnt lgkmcnt(3)
  v_mfma_f32_32x32x16_bf16 v[160:175], v[56:59], v[192:195], v[160:175]
  s_waitcnt lgkmcnt(2)
  v_mfma_f32_32x32x16_bf16 v[160:175], v[60:63], v[196:199], v[160:175]
  s_waitcnt lgkmcnt(1)
  v_mfma_f32_32x32x16_bf16 v[160:175], v[64:67], v[200:203], v[160:175]
  s_waitcnt lgkmcnt(0)
  v_mfma_f32_32x32x16_bf16 v[160:175], v[68:71], v[204:207], v[160:175]
  s_cmp_lg_u32 s34, s81
  s_cbranch_scc1 L_noz_53
  s_barrier
  s_lshl_b32 s20, s5, 7
  v_lshlrev_b32 v3, 4, v4
  v_add_u32 v3, s20, v3
  ds_read_b128 v[176:179], v3 offset:0
  ds_read_b128 v[180:183], v3 offset:32
  ds_read_b128 v[184:187], v3 offset:64
  ds_read_b128 v[188:191], v3 offset:96
  s_and_b32 s20, s33, 31
  v_and_b32 v3, 31, v1
  v_cmp_eq_u32 vcc, s20, v3
  s_nop 0
  s_and_saveexec_b64 s[86:87], vcc
  s_waitcnt lgkmcnt(0)
  v_add_f32 v160, v160, v176
  v_add_f32 v161, v161, v177
  v_add_f32 v162, v162, v178
  v_add_f32 v163, v163, v179
  v_add_f32 v164, v164, v180
  v_add_f32 v165, v165, v181
  v_add_f32 v166, v166, v182
  v_add_f32 v167, v167, v183
  v_add_f32 v168, v168, v184
  v_add_f32 v169, v169, v185
  v_add_f32 v170, v170, v186
  v_add_f32 v171, v171, v187
  v_add_f32 v172, v172, v188
  v_add_f32 v173, v173, v189
  v_add_f32 v174, v174, v190
  v_add_f32 v175, v175, v191
  s_mov_b64 exec, s[86:87]
L_noz_53:
  s_nop 9
  v_cvt_pk_bf16_f32 v136, v160, v161
  v_cvt_pk_bf16_f32 v137, v162, v163
  v_cvt_pk_bf16_f32 v138, v164, v165
  v_cvt_pk_bf16_f32 v139, v166, v167
  v_cvt_pk_bf16_f32 v140, v168, v169
  v_cvt_pk_bf16_f32 v141, v170, v171
  v_cvt_pk_bf16_f32 v142, v172, v173
  v_cvt_pk_bf16_f32 v143, v174, v175
  v_permlane32_swap_b32 v136, v138
  v_permlane32_swap_b32 v137, v139
  buffer_store_dwordx4 v[136:139], v247, s[64:67], s80 offen offset:0
  v_permlane32_swap_b32 v140, v142
  v_permlane32_swap_b32 v141, v143
  buffer_store_dwordx4 v[140:143], v247, s[64:67], s80 offen offset:32
  s_branch L_end
L_p3help:
  s_or_b32 s20, s2, s14
  s_cmp_lg_u32 s20, 0
  s_cbranch_scc1 L_noep
  v_mov_b32 v200, s7
  v_mov_b32 v201, 16384
  s_mov_b64 exec, 1
  buffer_store_dword v200, v201, s[48:51], 0 offen sc1
  s_mov_b64 exec, -1
L_noep:
  s_cmp_lg_u32 s34, s81
  s_cbranch_scc1 L_end
  s_waitcnt vmcnt(0)
  v_min3_u32 v3, v10, v14, v18
  v_max3_u32 v4, v10, v14, v18
  v_min3_u32 v3, v3, v22, v26
  v_max3_u32 v4, v4, v22, v26
  v_min3_u32 v3, v3, v30, v34
  v_max3_u32 v4, v4, v30, v34
  v_min3_u32 v3, v3, v38, v42
  v_max3_u32 v4, v4, v38, v42
  v_min3_u32 v3, v3, v46, v50
  v_max3_u32 v4, v4, v46, v50
  v_xor_b32 v3, s7, v3
  v_xor_b32 v4, s7, v4
  v_or_b32 v3, v3, v4
  v_cmp_ne_u32 vcc, 0, v3
  s_cbranch_vccz L_ok_55
L_rt_54:
  s_and_b32 s20, s4, 3
  s_lshl_b32 s20, s20, 10
  s_add_u32 s20, s20, 65536
  s_add_u32 s21, s20, 172032
  s_mul_i32 s22, s14, 45056
  s_add_u32 s20, s20, s22
  buffer_load_dwordx4 v[8:11], v2, s[48:51], s20 offen sc1
  s_add_u32 s20, s20, 4096
  buffer_load_dwordx4 v[12:15], v2, s[48:51], s20 offen sc1
  s_add_u32 s20, s20, 4096
  buffer_load_dwordx4 v[16:19], v2, s[48:51], s20 offen sc1
  s_add_u32 s20, s20, 4096
  buffer_load_dwordx4 v[20:23], v2, s[48:51], s20 offen sc1
  s_add_u32 s20, s20, 4096
  buffer_load_dwordx4 v[24:27], v2, s[48:51], s20 offen sc1
  s_add_u32 s20, s20, 4096
  buffer_load_dwordx4 v[28:31], v2, s[48:51], s20 offen sc1
  s_add_u32 s20, s20, 4096
  buffer_load_dwordx4 v[32:35], v2, s[48:51], s20 offen sc1
  s_add_u32 s20, s20, 4096
  buffer_load_dwordx4 v[36:39], v2, s[48:51], s20 offen sc1
  s_add_u32 s20, s20, 4096
  buffer_load_dwordx4 v[40:43], v2, s[48:51], s20 offen sc1
  s_add_u32 s20, s20, 4096
  buffer_load_dwordx4 v[44:47], v2, s[48:51], s20 offen sc1
  s_add_u32 s20, s20, 4096
  s_min_u32 s20, s20, s21
  buffer_load_dwordx4 v[48:51], v2, s[48:51], s20 offen sc1
  s_add_u32 s20, s20, 4096
  s_waitcnt vmcnt(0)
  v_min3_u32 v3, v10, v14, v18
  v_max3_u32 v4, v10, v14, v18
  v_min3_u32 v3, v3, v22, v26
  v_max3_u32 v4, v4, v22, v26
  v_min3_u32 v3, v3, v30, v34
  v_max3_u32 v4, v4, v30, v34
  v_min3_u32 v3, v3, v38, v42
  v_max3_u32 v4, v4, v38, v42
  v_min3_u32 v3, v3, v46, v50
  v_max3_u32 v4, v4, v46, v50
  v_xor_b32 v3, s7, v3
  v_xor_b32 v4, s7, v4
  v_or_b32 v3, v3, v4
  v_cmp_ne_u32 vcc, 0, v3
  s_add_u32 s88, s88, 1
  s_cmp_gt_u32 s88, 20000
  s_cbranch_scc1 L_end
  s_cbranch_vccnz L_rt_54
L_ok_55:
  s_cmp_eq_u32 s14, 3
  s_cselect_b32 s20, 0, 1.0
  v_add_f32 v8, v8, v12
  v_add_f32 v9, v9, v13
  v_add_f32 v8, v8, v16
  v_add_f32 v9, v9, v17
  v_add_f32 v8, v8, v20
  v_add_f32 v9, v9, v21
  v_add_f32 v8, v8, v24
  v_add_f32 v9, v9, v25
  v_add_f32 v8, v8, v28
  v_add_f32 v9, v9, v29
  v_add_f32 v8, v8, v32
  v_add_f32 v9, v9, v33
  v_add_f32 v8, v8, v36
  v_add_f32 v9, v9, v37
  v_add_f32 v8, v8, v40
  v_add_f32 v9, v9, v41
  v_add_f32 v8, v8, v44
  v_add_f32 v9, v9, v45
  v_fmac_f32 v8, s20, v48
  v_fmac_f32 v9, s20, v49
  s_lshl_b32 s20, s14, 9
  s_add_u32 s20, s20, 1024
  v_lshl_add_u32 v3, v1, 3, s20
  ds_write_b64 v3, v[8:9]
  s_waitcnt lgkmcnt(0)
  s_barrier
  s_cmp_lg_u32 s5, 4
  s_cbranch_scc1 L_hb_56
  ds_read_b64 v[10:11], v3 offset:512
  ds_read_b64 v[12:13], v3 offset:1024
  ds_read_b64 v[14:15], v3 offset:1536
  s_waitcnt lgkmcnt(0)
  v_add_f32 v8, v8, v10
  v_add_f32 v9, v9, v11
  v_add_f32 v12, v12, v14
  v_add_f32 v13, v13, v15
  v_add_f32 v8, v8, v12
  v_add_f32 v9, v9, v13
  v_cvt_pk_bf16_f32 v8, v8, v8
  v_and_b32 v8, 0xffff0000, v8
  v_cvt_pk_bf16_f32 v9, v9, v9
  v_and_b32 v9, 0xffff0000, v9
  s_and_b32 s20, s9, 0xffff0000
  s_ashr_i32 s21, s20, 31
  s_not_b32 s21, s21
  s_or_b32 s21, s21, 0x80000000
  s_xor_b32 s20, s20, s21
  s_and_b32 s20, s20, 0xffff0000
  v_mov_b32 v3, s20
  v_mul_f32 v3, 0xbfb8aa3b, v3
  v_exp_f32 v3, v3
  s_nop 0
  v_add_f32 v3, 1.0, v3
  v_rcp_f32 v3, v3
  s_nop 0
  v_cvt_pk_bf16_f32 v3, v3, v3
  v_and_b32 v3, 0xffff0000, v3
  v_mul_f32 v8, v8, v3
  v_mul_f32 v9, v9, v3
  v_cvt_pk_bf16_f32 v8, v8, v8
  v_and_b32 v8, 0xffff0000, v8
  v_cvt_pk_bf16_f32 v9, v9, v9
  v_and_b32 v9, 0xffff0000, v9
  v_lshrrev_b32 v3, 5, v1
  v_lshlrev_b32 v3, 8, v3
  v_and_b32 v4, 31, v1
  v_lshl_add_u32 v3, v4, 2, v3
  ds_write_b32 v3, v8
  ds_write_b32 v3, v9 offset:128
  s_waitcnt lgkmcnt(0)
L_hb_56:
  s_barrier
L_end:
L_exit:
  s_endpgm
L_codeend:
L_slow:
  s_waitcnt vmcnt(0)
  v_mov_b32 v240, 0xf149f2ca
  v_mov_b32 v241, 0xf149f2ca
  v_mov_b32 v5, 0xf149f2ca
  s_cmp_eq_u32 s16, 0
  s_cbranch_scc1 L_s_57
  v_mfma_f32_32x32x16_bf16 v[160:175], v[8:11], v[88:91], 0
  s_nop 11
  v_max3_f32 v240, v160, v161, v240
  v_max3_f32 v240, v162, v163, v240
  v_max3_f32 v240, v164, v165, v240
  v_max3_f32 v240, v166, v167, v240
  v_max3_f32 v240, v168, v169, v240
  v_max3_f32 v240, v170, v171, v240
  v_max3_f32 v240, v172, v173, v240
  v_max3_f32 v240, v174, v175, v240
  v_mfma_f32_32x32x16_bf16 v[160:175], v[8:11], v[92:95], 0
  s_nop 11
  v_max3_f32 v241, v160, v161, v241
  v_max3_f32 v241, v162, v163, v241
  v_max3_f32 v241, v164, v165, v241
  v_max3_f32 v241, v166, v167, v241
  v_max3_f32 v241, v168, v169, v241
  v_max3_f32 v241, v170, v171, v241
  v_max3_f32 v241, v172, v173, v241
  v_max3_f32 v241, v174, v175, v241
  v_mfma_f32_32x32x16_bf16 v[160:175], v[20:23], v[88:91], 0
  s_nop 11
  v_max3_f32 v240, v160, v161, v240
  v_max3_f32 v240, v162, v163, v240
  v_max3_f32 v240, v164, v165, v240
  v_max3_f32 v240, v166, v167, v240
  v_max3_f32 v240, v168, v169, v240
  v_max3_f32 v240, v170, v171, v240
  v_max3_f32 v240, v172, v173, v240
  v_max3_f32 v240, v174, v175, v240
  v_mfma_f32_32x32x16_bf16 v[160:175], v[20:23], v[92:95], 0
  s_nop 11
  v_max3_f32 v241, v160, v161, v241
  v_max3_f32 v241, v162, v163, v241
  v_max3_f32 v241, v164, v165, v241
  v_max3_f32 v241, v166, v167, v241
  v_max3_f32 v241, v168, v169, v241
  v_max3_f32 v241, v170, v171, v241
  v_max3_f32 v241, v172, v173, v241
  v_max3_f32 v241, v174, v175, v241
L_s_57:
  s_cmp_eq_u32 s15, 0
  s_cbranch_scc1 L_s_58
  v_mfma_f32_32x32x16_bf16 v[160:175], v[32:35], v[88:91], 0
  s_nop 11
  v_max3_f32 v240, v160, v161, v240
  v_max3_f32 v240, v162, v163, v240
  v_max3_f32 v240, v164, v165, v240
  v_max3_f32 v240, v166, v167, v240
  v_max3_f32 v240, v168, v169, v240
  v_max3_f32 v240, v170, v171, v240
  v_max3_f32 v240, v172, v173, v240
  v_max3_f32 v240, v174, v175, v240
  v_mfma_f32_32x32x16_bf16 v[160:175], v[32:35], v[92:95], 0
  s_nop 11
  v_max3_f32 v241, v160, v161, v241
  v_max3_f32 v241, v162, v163, v241
  v_max3_f32 v241, v164, v165, v241
  v_max3_f32 v241, v166, v167, v241
  v_max3_f32 v241, v168, v169, v241
  v_max3_f32 v241, v170, v171, v241
  v_max3_f32 v241, v172, v173, v241
  v_max3_f32 v241, v174, v175, v241
  v_mfma_f32_32x32x16_bf16 v[160:175], v[44:47], v[88:91], 0
  s_nop 11
  v_max3_f32 v240, v160, v161, v240
  v_max3_f32 v240, v162, v163, v240
  v_max3_f32 v240, v164, v165, v240
  v_max3_f32 v240, v166, v167, v240
  v_max3_f32 v240, v168, v169, v240
  v_max3_f32 v240, v170, v171, v240
  v_max3_f32 v240, v172, v173, v240
  v_max3_f32 v240, v174, v175, v240
  v_mfma_f32_32x32x16_bf16 v[160:175], v[44:47], v[92:95], 0
  s_nop 11
  v_max3_f32 v241, v160, v161, v241
  v_max3_f32 v241, v162, v163, v241
  v_max3_f32 v241, v164, v165, v241
  v_max3_f32 v241, v166, v167, v241
  v_max3_f32 v241, v168, v169, v241
  v_max3_f32 v241, v170, v171, v241
  v_max3_f32 v241, v172, v173, v241
  v_max3_f32 v241, v174, v175, v241
  s_branch L_s_59
L_s_58:
  v_mfma_f32_32x32x16_bf16 v[160:175], v[56:59], v[88:91], 0
  s_lshl_b32 s20, -1, 0
  s_lshl_b32 s21, -1, 4
  s_nop 9
  v_cndmask_b32_e64 v160, v5, v160, s[20:21]
  s_lshl_b32 s20, -1, 1
  s_lshl_b32 s21, -1, 5
  v_cndmask_b32_e64 v161, v5, v161, s[20:21]
  s_lshl_b32 s20, -1, 2
  s_lshl_b32 s21, -1, 6
  v_cndmask_b32_e64 v162, v5, v162, s[20:21]
  s_lshl_b32 s20, -1, 3
  s_lshl_b32 s21, -1, 7
  v_cndmask_b32_e64 v163, v5, v163, s[20:21]
  s_lshl_b32 s20, -1, 8
  s_lshl_b32 s21, -1, 12
  v_cndmask_b32_e64 v164, v5, v164, s[20:21]
  s_lshl_b32 s20, -1, 9
  s_lshl_b32 s21, -1, 13
  v_cndmask_b32_e64 v165, v5, v165, s[20:21]
  s_lshl_b32 s20, -1, 10
  s_lshl_b32 s21, -1, 14
  v_cndmask_b32_e64 v166, v5, v166, s[20:21]
  s_lshl_b32 s20, -1, 11
  s_lshl_b32 s21, -1, 15
  v_cndmask_b32_e64 v167, v5, v167, s[20:21]
  s_lshl_b32 s20, -1, 16
  s_lshl_b32 s21, -1, 20
  v_cndmask_b32_e64 v168, v5, v168, s[20:21]
  s_lshl_b32 s20, -1, 17
  s_lshl_b32 s21, -1, 21
  v_cndmask_b32_e64 v169, v5, v169, s[20:21]
  s_lshl_b32 s20, -1, 18
  s_lshl_b32 s21, -1, 22
  v_cndmask_b32_e64 v170, v5, v170, s[20:21]
  s_lshl_b32 s20, -1, 19
  s_lshl_b32 s21, -1, 23
  v_cndmask_b32_e64 v171, v5, v171, s[20:21]
  s_lshl_b32 s20, -1, 24
  s_lshl_b32 s21, -1, 28
  v_cndmask_b32_e64 v172, v5, v172, s[20:21]
  s_lshl_b32 s20, -1, 25
  s_lshl_b32 s21, -1, 29
  v_cndmask_b32_e64 v173, v5, v173, s[20:21]
  s_lshl_b32 s20, -1, 26
  s_lshl_b32 s21, -1, 30
  v_cndmask_b32_e64 v174, v5, v174, s[20:21]
  s_lshl_b32 s20, -1, 27
  s_lshl_b32 s21, -1, 31
  v_cndmask_b32_e64 v175, v5, v175, s[20:21]
  v_max3_f32 v240, v160, v161, v240
  v_max3_f32 v240, v162, v163, v240
  v_max3_f32 v240, v164, v165, v240
  v_max3_f32 v240, v166, v167, v240
  v_max3_f32 v240, v168, v169, v240
  v_max3_f32 v240, v170, v171, v240
  v_max3_f32 v240, v172, v173, v240
  v_max3_f32 v240, v174, v175, v240
  v_mfma_f32_32x32x16_bf16 v[160:175], v[68:71], v[92:95], 0
  s_lshl_b32 s20, -1, 0
  s_lshl_b32 s21, -1, 4
  s_nop 9
  v_cndmask_b32_e64 v160, v5, v160, s[20:21]
  s_lshl_b32 s20, -1, 1
  s_lshl_b32 s21, -1, 5
  v_cndmask_b32_e64 v161, v5, v161, s[20:21]
  s_lshl_b32 s20, -1, 2
  s_lshl_b32 s21, -1, 6
  v_cndmask_b32_e64 v162, v5, v162, s[20:21]
  s_lshl_b32 s20, -1, 3
  s_lshl_b32 s21, -1, 7
  v_cndmask_b32_e64 v163, v5, v163, s[20:21]
  s_lshl_b32 s20, -1, 8
  s_lshl_b32 s21, -1, 12
  v_cndmask_b32_e64 v164, v5, v164, s[20:21]
  s_lshl_b32 s20, -1, 9
  s_lshl_b32 s21, -1, 13
  v_cndmask_b32_e64 v165, v5, v165, s[20:21]
  s_lshl_b32 s20, -1, 10
  s_lshl_b32 s21, -1, 14
  v_cndmask_b32_e64 v166, v5, v166, s[20:21]
  s_lshl_b32 s20, -1, 11
  s_lshl_b32 s21, -1, 15
  v_cndmask_b32_e64 v167, v5, v167, s[20:21]
  s_lshl_b32 s20, -1, 16
  s_lshl_b32 s21, -1, 20
  v_cndmask_b32_e64 v168, v5, v168, s[20:21]
  s_lshl_b32 s20, -1, 17
  s_lshl_b32 s21, -1, 21
  v_cndmask_b32_e64 v169, v5, v169, s[20:21]
  s_lshl_b32 s20, -1, 18
  s_lshl_b32 s21, -1, 22
  v_cndmask_b32_e64 v170, v5, v170, s[20:21]
  s_lshl_b32 s20, -1, 19
  s_lshl_b32 s21, -1, 23
  v_cndmask_b32_e64 v171, v5, v171, s[20:21]
  s_lshl_b32 s20, -1, 24
  s_lshl_b32 s21, -1, 28
  v_cndmask_b32_e64 v172, v5, v172, s[20:21]
  s_lshl_b32 s20, -1, 25
  s_lshl_b32 s21, -1, 29
  v_cndmask_b32_e64 v173, v5, v173, s[20:21]
  s_lshl_b32 s20, -1, 26
  s_lshl_b32 s21, -1, 30
  v_cndmask_b32_e64 v174, v5, v174, s[20:21]
  s_lshl_b32 s20, -1, 27
  s_lshl_b32 s21, -1, 31
  v_cndmask_b32_e64 v175, v5, v175, s[20:21]
  v_max3_f32 v241, v160, v161, v241
  v_max3_f32 v241, v162, v163, v241
  v_max3_f32 v241, v164, v165, v241
  v_max3_f32 v241, v166, v167, v241
  v_max3_f32 v241, v168, v169, v241
  v_max3_f32 v241, v170, v171, v241
  v_max3_f32 v241, v172, v173, v241
  v_max3_f32 v241, v174, v175, v241
  v_mfma_f32_32x32x16_bf16 v[160:175], v[56:59], v[92:95], 0
  s_nop 11
  v_max3_f32 v241, v160, v161, v241
  v_max3_f32 v241, v162, v163, v241
  v_max3_f32 v241, v164, v165, v241
  v_max3_f32 v241, v166, v167, v241
  v_max3_f32 v241, v168, v169, v241
  v_max3_f32 v241, v170, v171, v241
  v_max3_f32 v241, v172, v173, v241
  v_max3_f32 v241, v174, v175, v241
  s_cmp_eq_u32 s17, 0
  s_cbranch_scc1 L_s_59
  v_mfma_f32_32x32x16_bf16 v[160:175], v[44:47], v[88:91], 0
  s_nop 11
  v_max3_f32 v240, v160, v161, v240
  v_max3_f32 v240, v162, v163, v240
  v_max3_f32 v240, v164, v165, v240
  v_max3_f32 v240, v166, v167, v240
  v_max3_f32 v240, v168, v169, v240
  v_max3_f32 v240, v170, v171, v240
  v_max3_f32 v240, v172, v173, v240
  v_max3_f32 v240, v174, v175, v240
  v_mfma_f32_32x32x16_bf16 v[160:175], v[32:35], v[88:91], 0
  s_lshl_b32 s20, -1, 0
  s_lshl_b32 s21, -1, 4
  s_nop 9
  v_cndmask_b32_e64 v160, v160, v5, s[20:21]
  s_lshl_b32 s20, -1, 1
  s_lshl_b32 s21, -1, 5
  v_cndmask_b32_e64 v161, v161, v5, s[20:21]
  s_lshl_b32 s20, -1, 2
  s_lshl_b32 s21, -1, 6
  v_cndmask_b32_e64 v162, v162, v5, s[20:21]
  s_lshl_b32 s20, -1, 3
  s_lshl_b32 s21, -1, 7
  v_cndmask_b32_e64 v163, v163, v5, s[20:21]
  s_lshl_b32 s20, -1, 8
  s_lshl_b32 s21, -1, 12
  v_cndmask_b32_e64 v164, v164, v5, s[20:21]
  s_lshl_b32 s20, -1, 9
  s_lshl_b32 s21, -1, 13
  v_cndmask_b32_e64 v165, v165, v5, s[20:21]
  s_lshl_b32 s20, -1, 10
  s_lshl_b32 s21, -1, 14
  v_cndmask_b32_e64 v166, v166, v5, s[20:21]
  s_lshl_b32 s20, -1, 11
  s_lshl_b32 s21, -1, 15
  v_cndmask_b32_e64 v167, v167, v5, s[20:21]
  s_lshl_b32 s20, -1, 16
  s_lshl_b32 s21, -1, 20
  v_cndmask_b32_e64 v168, v168, v5, s[20:21]
  s_lshl_b32 s20, -1, 17
  s_lshl_b32 s21, -1, 21
  v_cndmask_b32_e64 v169, v169, v5, s[20:21]
  s_lshl_b32 s20, -1, 18
  s_lshl_b32 s21, -1, 22
  v_cndmask_b32_e64 v170, v170, v5, s[20:21]
  s_lshl_b32 s20, -1, 19
  s_lshl_b32 s21, -1, 23
  v_cndmask_b32_e64 v171, v171, v5, s[20:21]
  s_lshl_b32 s20, -1, 24
  s_lshl_b32 s21, -1, 28
  v_cndmask_b32_e64 v172, v172, v5, s[20:21]
  s_lshl_b32 s20, -1, 25
  s_lshl_b32 s21, -1, 29
  v_cndmask_b32_e64 v173, v173, v5, s[20:21]
  s_lshl_b32 s20, -1, 26
  s_lshl_b32 s21, -1, 30
  v_cndmask_b32_e64 v174, v174, v5, s[20:21]
  s_lshl_b32 s20, -1, 27
  s_lshl_b32 s21, -1, 31
  v_cndmask_b32_e64 v175, v175, v5, s[20:21]
  v_max3_f32 v240, v160, v161, v240
  v_max3_f32 v240, v162, v163, v240
  v_max3_f32 v240, v164, v165, v240
  v_max3_f32 v240, v166, v167, v240
  v_max3_f32 v240, v168, v169, v240
  v_max3_f32 v240, v170, v171, v240
  v_max3_f32 v240, v172, v173, v240
  v_max3_f32 v240, v174, v175, v240
  v_mfma_f32_32x32x16_bf16 v[160:175], v[44:47], v[92:95], 0
  s_lshl_b32 s20, -1, 0
  s_lshl_b32 s21, -1, 4
  s_nop 9
  v_cndmask_b32_e64 v160, v160, v5, s[20:21]
  s_lshl_b32 s20, -1, 1
  s_lshl_b32 s21, -1, 5
  v_cndmask_b32_e64 v161, v161, v5, s[20:21]
  s_lshl_b32 s20, -1, 2
  s_lshl_b32 s21, -1, 6
  v_cndmask_b32_e64 v162, v162, v5, s[20:21]
  s_lshl_b32 s20, -1, 3
  s_lshl_b32 s21, -1, 7
  v_cndmask_b32_e64 v163, v163, v5, s[20:21]
  s_lshl_b32 s20, -1, 8
  s_lshl_b32 s21, -1, 12
  v_cndmask_b32_e64 v164, v164, v5, s[20:21]
  s_lshl_b32 s20, -1, 9
  s_lshl_b32 s21, -1, 13
  v_cndmask_b32_e64 v165, v165, v5, s[20:21]
  s_lshl_b32 s20, -1, 10
  s_lshl_b32 s21, -1, 14
  v_cndmask_b32_e64 v166, v166, v5, s[20:21]
  s_lshl_b32 s20, -1, 11
  s_lshl_b32 s21, -1, 15
  v_cndmask_b32_e64 v167, v167, v5, s[20:21]
  s_lshl_b32 s20, -1, 16
  s_lshl_b32 s21, -1, 20
  v_cndmask_b32_e64 v168, v168, v5, s[20:21]
  s_lshl_b32 s20, -1, 17
  s_lshl_b32 s21, -1, 21
  v_cndmask_b32_e64 v169, v169, v5, s[20:21]
  s_lshl_b32 s20, -1, 18
  s_lshl_b32 s21, -1, 22
  v_cndmask_b32_e64 v170, v170, v5, s[20:21]
  s_lshl_b32 s20, -1, 19
  s_lshl_b32 s21, -1, 23
  v_cndmask_b32_e64 v171, v171, v5, s[20:21]
  s_lshl_b32 s20, -1, 24
  s_lshl_b32 s21, -1, 28
  v_cndmask_b32_e64 v172, v172, v5, s[20:21]
  s_lshl_b32 s20, -1, 25
  s_lshl_b32 s21, -1, 29
  v_cndmask_b32_e64 v173, v173, v5, s[20:21]
  s_lshl_b32 s20, -1, 26
  s_lshl_b32 s21, -1, 30
  v_cndmask_b32_e64 v174, v174, v5, s[20:21]
  s_lshl_b32 s20, -1, 27
  s_lshl_b32 s21, -1, 31
  v_cndmask_b32_e64 v175, v175, v5, s[20:21]
  v_max3_f32 v241, v160, v161, v241
  v_max3_f32 v241, v162, v163, v241
  v_max3_f32 v241, v164, v165, v241
  v_max3_f32 v241, v166, v167, v241
  v_max3_f32 v241, v168, v169, v241
  v_max3_f32 v241, v170, v171, v241
  v_max3_f32 v241, v172, v173, v241
  v_max3_f32 v241, v174, v175, v241
L_s_59:
  v_mov_b32 v2, v240
  v_mov_b32 v3, v241
  s_nop 0
  v_permlane32_swap_b32 v240, v2
  v_permlane32_swap_b32 v241, v3
  v_max_f32 v240, v240, v2
  v_max_f32 v241, v241, v3
  v_sub_f32 v96, 0, v240
  v_sub_f32 v97, 0, v240
  v_sub_f32 v98, 0, v240
  v_sub_f32 v99, 0, v240
  v_sub_f32 v100, 0, v240
  v_sub_f32 v101, 0, v240
  v_sub_f32 v102, 0, v240
  v_sub_f32 v103, 0, v240
  v_sub_f32 v104, 0, v240
  v_sub_f32 v105, 0, v240
  v_sub_f32 v106, 0, v240
  v_sub_f32 v107, 0, v240
  v_sub_f32 v108, 0, v240
  v_sub_f32 v109, 0, v240
  v_sub_f32 v110, 0, v240
  v_sub_f32 v111, 0, v240
  v_sub_f32 v112, 0, v241
  v_sub_f32 v113, 0, v241
  v_sub_f32 v114, 0, v241
  v_sub_f32 v115, 0, v241
  v_sub_f32 v116, 0, v241
  v_sub_f32 v117, 0, v241
  v_sub_f32 v118, 0, v241
  v_sub_f32 v119, 0, v241
  v_sub_f32 v120, 0, v241
  v_sub_f32 v121, 0, v241
  v_sub_f32 v122, 0, v241
  v_sub_f32 v123, 0, v241
  v_sub_f32 v124, 0, v241
  v_sub_f32 v125, 0, v241
  v_sub_f32 v126, 0, v241
  v_sub_f32 v127, 0, v241
  v_mov_b32 v128, 0
  v_mov_b32 v129, 0
  v_mov_b32 v130, 0
  v_mov_b32 v131, 0
  v_mov_b32 v132, 0
  v_mov_b32 v133, 0
  v_mov_b32 v134, 0
  v_mov_b32 v135, 0
  v_mov_b32 v136, 0
  v_mov_b32 v137, 0
  v_mov_b32 v138, 0
  v_mov_b32 v139, 0
  v_mov_b32 v140, 0
  v_mov_b32 v141, 0
  v_mov_b32 v142, 0
  v_mov_b32 v143, 0
  v_mov_b32 v144, 0
  v_mov_b32 v145, 0
  v_mov_b32 v146, 0
  v_mov_b32 v147, 0
  v_mov_b32 v148, 0
  v_mov_b32 v149, 0
  v_mov_b32 v150, 0
  v_mov_b32 v151, 0
  v_mov_b32 v152, 0
  v_mov_b32 v153, 0
  v_mov_b32 v154, 0
  v_mov_b32 v155, 0
  v_mov_b32 v156, 0
  v_mov_b32 v157, 0
  v_mov_b32 v158, 0
  v_mov_b32 v159, 0
  s_cmp_eq_u32 s16, 0
  s_cbranch_scc1 L_s_60
  v_mfma_f32_32x32x16_bf16 v[160:175], v[8:11], v[88:91], v[96:111]
  v_mfma_f32_32x32x16_bf16 v[176:191], v[8:11], v[92:95], v[112:127]
  s_nop 10
  v_exp_f32 v160, v160
  v_exp_f32 v161, v161
  v_exp_f32 v162, v162
  v_exp_f32 v163, v163
  v_exp_f32 v164, v164
  v_exp_f32 v165, v165
  v_exp_f32 v166, v166
  v_exp_f32 v167, v167
  v_exp_f32 v168, v168
  v_exp_f32 v169, v169
  v_exp_f32 v170, v170
  v_exp_f32 v171, v171
  v_exp_f32 v172, v172
  v_exp_f32 v173, v173
  v_exp_f32 v174, v174
  v_exp_f32 v175, v175
  v_cvt_pk_bf16_f32 v160, v160, v161
  v_cvt_pk_bf16_f32 v161, v162, v163
  v_cvt_pk_bf16_f32 v162, v164, v165
  v_cvt_pk_bf16_f32 v163, v166, v167
  v_cvt_pk_bf16_f32 v164, v168, v169
  v_cvt_pk_bf16_f32 v165, v170, v171
  v_cvt_pk_bf16_f32 v166, v172, v173
  v_cvt_pk_bf16_f32 v167, v174, v175
  v_mfma_f32_32x32x16_bf16 v[192:207], v[20:23], v[88:91], v[96:111]
  v_exp_f32 v176, v176
  v_exp_f32 v177, v177
  v_exp_f32 v178, v178
  v_exp_f32 v179, v179
  v_exp_f32 v180, v180
  v_mfma_f32_32x32x16_bf16 v[128:143], v[12:15], v[160:163], v[128:143]
  v_exp_f32 v181, v181
  v_exp_f32 v182, v182
  v_exp_f32 v183, v183
  v_exp_f32 v184, v184
  v_exp_f32 v185, v185
  v_mfma_f32_32x32x16_bf16 v[128:143], v[16:19], v[164:167], v[128:143]
  v_exp_f32 v186, v186
  v_exp_f32 v187, v187
  v_exp_f32 v188, v188
  v_exp_f32 v189, v189
  v_exp_f32 v190, v190
  v_exp_f32 v191, v191
  v_cvt_pk_bf16_f32 v176, v176, v177
  v_cvt_pk_bf16_f32 v177, v178, v179
  v_cvt_pk_bf16_f32 v178, v180, v181
  v_cvt_pk_bf16_f32 v179, v182, v183
  v_cvt_pk_bf16_f32 v180, v184, v185
  v_cvt_pk_bf16_f32 v181, v186, v187
  v_cvt_pk_bf16_f32 v182, v188, v189
  v_cvt_pk_bf16_f32 v183, v190, v191
  v_mfma_f32_32x32x16_bf16 v[160:175], v[20:23], v[92:95], v[112:127]
  v_exp_f32 v192, v192
  v_exp_f32 v193, v193
  v_exp_f32 v194, v194
  v_exp_f32 v195, v195
  v_exp_f32 v196, v196
  v_mfma_f32_32x32x16_bf16 v[144:159], v[12:15], v[176:179], v[144:159]
  v_exp_f32 v197, v197
  v_exp_f32 v198, v198
  v_exp_f32 v199, v199
  v_exp_f32 v200, v200
  v_exp_f32 v201, v201
  v_mfma_f32_32x32x16_bf16 v[144:159], v[16:19], v[180:183], v[144:159]
  v_exp_f32 v202, v202
  v_exp_f32 v203, v203
  v_exp_f32 v204, v204
  v_exp_f32 v205, v205
  v_exp_f32 v206, v206
  v_exp_f32 v207, v207
  v_cvt_pk_bf16_f32 v192, v192, v193
  v_cvt_pk_bf16_f32 v193, v194, v195
  v_cvt_pk_bf16_f32 v194, v196, v197
  v_cvt_pk_bf16_f32 v195, v198, v199
  v_cvt_pk_bf16_f32 v196, v200, v201
  v_cvt_pk_bf16_f32 v197, v202, v203
  v_cvt_pk_bf16_f32 v198, v204, v205
  v_cvt_pk_bf16_f32 v199, v206, v207
  v_mfma_f32_32x32x16_bf16 v[128:143], v[24:27], v[192:195], v[128:143]
  v_exp_f32 v160, v160
  v_exp_f32 v161, v161
  v_exp_f32 v162, v162
  v_exp_f32 v163, v163
  v_exp_f32 v164, v164
  v_mfma_f32_32x32x16_bf16 v[128:143], v[28:31], v[196:199], v[128:143]
  v_exp_f32 v165, v165
  v_exp_f32 v166, v166
  v_exp_f32 v167, v167
  v_exp_f32 v168, v168
  v_exp_f32 v169, v169
  v_exp_f32 v170, v170
  v_exp_f32 v171, v171
  v_exp_f32 v172, v172
  v_exp_f32 v173, v173
  v_exp_f32 v174, v174
  v_exp_f32 v175, v175
  v_cvt_pk_bf16_f32 v160, v160, v161
  v_cvt_pk_bf16_f32 v161, v162, v163
  v_cvt_pk_bf16_f32 v162, v164, v165
  v_cvt_pk_bf16_f32 v163, v166, v167
  v_cvt_pk_bf16_f32 v164, v168, v169
  v_cvt_pk_bf16_f32 v165, v170, v171
  v_cvt_pk_bf16_f32 v166, v172, v173
  v_cvt_pk_bf16_f32 v167, v174, v175
  v_mfma_f32_32x32x16_bf16 v[144:159], v[24:27], v[160:163], v[144:159]
  s_nop 0
  v_mfma_f32_32x32x16_bf16 v[144:159], v[28:31], v[164:167], v[144:159]
L_s_60:
  s_cmp_eq_u32 s15, 0
  s_cbranch_scc1 L_s_61
  v_mfma_f32_32x32x16_bf16 v[160:175], v[32:35], v[88:91], v[96:111]
  v_mfma_f32_32x32x16_bf16 v[176:191], v[32:35], v[92:95], v[112:127]
  s_nop 10
  v_exp_f32 v160, v160
  v_exp_f32 v161, v161
  v_exp_f32 v162, v162
  v_exp_f32 v163, v163
  v_exp_f32 v164, v164
  v_exp_f32 v165, v165
  v_exp_f32 v166, v166
  v_exp_f32 v167, v167
  v_exp_f32 v168, v168
  v_exp_f32 v169, v169
  v_exp_f32 v170, v170
  v_exp_f32 v171, v171
  v_exp_f32 v172, v172
  v_exp_f32 v173, v173
  v_exp_f32 v174, v174
  v_exp_f32 v175, v175
  v_cvt_pk_bf16_f32 v160, v160, v161
  v_cvt_pk_bf16_f32 v161, v162, v163
  v_cvt_pk_bf16_f32 v162, v164, v165
  v_cvt_pk_bf16_f32 v163, v166, v167
  v_cvt_pk_bf16_f32 v164, v168, v169
  v_cvt_pk_bf16_f32 v165, v170, v171
  v_cvt_pk_bf16_f32 v166, v172, v173
  v_cvt_pk_bf16_f32 v167, v174, v175
  v_mfma_f32_32x32x16_bf16 v[192:207], v[44:47], v[88:91], v[96:111]
  v_exp_f32 v176, v176
  v_exp_f32 v177, v177
  v_exp_f32 v178, v178
  v_exp_f32 v179, v179
  v_exp_f32 v180, v180
  v_mfma_f32_32x32x16_bf16 v[128:143], v[36:39], v[160:163], v[128:143]
  v_exp_f32 v181, v181
  v_exp_f32 v182, v182
  v_exp_f32 v183, v183
  v_exp_f32 v184, v184
  v_exp_f32 v185, v185
  v_mfma_f32_32x32x16_bf16 v[128:143], v[40:43], v[164:167], v[128:143]
  v_exp_f32 v186, v186
  v_exp_f32 v187, v187
  v_exp_f32 v188, v188
  v_exp_f32 v189, v189
  v_exp_f32 v190, v190
  v_exp_f32 v191, v191
  v_cvt_pk_bf16_f32 v176, v176, v177
  v_cvt_pk_bf16_f32 v177, v178, v179
  v_cvt_pk_bf16_f32 v178, v180, v181
  v_cvt_pk_bf16_f32 v179, v182, v183
  v_cvt_pk_bf16_f32 v180, v184, v185
  v_cvt_pk_bf16_f32 v181, v186, v187
  v_cvt_pk_bf16_f32 v182, v188, v189
  v_cvt_pk_bf16_f32 v183, v190, v191
  v_mfma_f32_32x32x16_bf16 v[160:175], v[44:47], v[92:95], v[112:127]
  v_exp_f32 v192, v192
  v_exp_f32 v193, v193
  v_exp_f32 v194, v194
  v_exp_f32 v195, v195
  v_exp_f32 v196, v196
  v_mfma_f32_32x32x16_bf16 v[144:159], v[36:39], v[176:179], v[144:159]
  v_exp_f32 v197, v197
  v_exp_f32 v198, v198
  v_exp_f32 v199, v199
  v_exp_f32 v200, v200
  v_exp_f32 v201, v201
  v_mfma_f32_32x32x16_bf16 v[144:159], v[40:43], v[180:183], v[144:159]
  v_exp_f32 v202, v202
  v_exp_f32 v203, v203
  v_exp_f32 v204, v204
  v_exp_f32 v205, v205
  v_exp_f32 v206, v206
  v_exp_f32 v207, v207
  v_cvt_pk_bf16_f32 v192, v192, v193
  v_cvt_pk_bf16_f32 v193, v194, v195
  v_cvt_pk_bf16_f32 v194, v196, v197
  v_cvt_pk_bf16_f32 v195, v198, v199
  v_cvt_pk_bf16_f32 v196, v200, v201
  v_cvt_pk_bf16_f32 v197, v202, v203
  v_cvt_pk_bf16_f32 v198, v204, v205
  v_cvt_pk_bf16_f32 v199, v206, v207
  v_mfma_f32_32x32x16_bf16 v[128:143], v[48:51], v[192:195], v[128:143]
  v_exp_f32 v160, v160
  v_exp_f32 v161, v161
  v_exp_f32 v162, v162
  v_exp_f32 v163, v163
  v_exp_f32 v164, v164
  v_mfma_f32_32x32x16_bf16 v[128:143], v[52:55], v[196:199], v[128:143]
  v_exp_f32 v165, v165
  v_exp_f32 v166, v166
  v_exp_f32 v167, v167
  v_exp_f32 v168, v168
  v_exp_f32 v169, v169
  v_exp_f32 v170, v170
  v_exp_f32 v171, v171
  v_exp_f32 v172, v172
  v_exp_f32 v173, v173
  v_exp_f32 v174, v174
  v_exp_f32 v175, v175
  v_cvt_pk_bf16_f32 v160, v160, v161
  v_cvt_pk_bf16_f32 v161, v162, v163
  v_cvt_pk_bf16_f32 v162, v164, v165
  v_cvt_pk_bf16_f32 v163, v166, v167
  v_cvt_pk_bf16_f32 v164, v168, v169
  v_cvt_pk_bf16_f32 v165, v170, v171
  v_cvt_pk_bf16_f32 v166, v172, v173
  v_cvt_pk_bf16_f32 v167, v174, v175
  v_mfma_f32_32x32x16_bf16 v[144:159], v[48:51], v[160:163], v[144:159]
  s_nop 0
  v_mfma_f32_32x32x16_bf16 v[144:159], v[52:55], v[164:167], v[144:159]
  s_branch L_s_62
L_s_61:
  v_mfma_f32_32x32x16_bf16 v[160:175], v[56:59], v[88:91], v[96:111]
  v_mfma_f32_32x32x16_bf16 v[176:191], v[68:71], v[92:95], v[112:127]
  s_nop 10
  v_exp_f32 v160, v160
  v_exp_f32 v161, v161
  v_exp_f32 v162, v162
  v_exp_f32 v163, v163
  v_exp_f32 v164, v164
  v_exp_f32 v165, v165
  v_exp_f32 v166, v166
  v_exp_f32 v167, v167
  v_exp_f32 v168, v168
  v_exp_f32 v169, v169
  v_exp_f32 v170, v170
  v_exp_f32 v171, v171
  v_exp_f32 v172, v172
  v_exp_f32 v173, v173
  v_exp_f32 v174, v174
  v_exp_f32 v175, v175
  v_cvt_pk_bf16_f32 v160, v160, v161
  v_cvt_pk_bf16_f32 v161, v162, v163
  v_cvt_pk_bf16_f32 v162, v164, v165
  v_cvt_pk_bf16_f32 v163, v166, v167
  v_cvt_pk_bf16_f32 v164, v168, v169
  v_cvt_pk_bf16_f32 v165, v170, v171
  v_cvt_pk_bf16_f32 v166, v172, v173
  v_cvt_pk_bf16_f32 v167, v174, v175
  v_bfi_b32 v160, v232, 0, v160
  v_bfi_b32 v161, v233, 0, v161
  v_bfi_b32 v162, v234, 0, v162
  v_bfi_b32 v163, v235, 0, v163
  v_bfi_b32 v164, v236, 0, v164
  v_bfi_b32 v165, v237, 0, v165
  v_bfi_b32 v166, v238, 0, v166
  v_bfi_b32 v167, v239, 0, v167
  v_mfma_f32_32x32x16_bf16 v[192:207], v[56:59], v[92:95], v[112:127]
  v_exp_f32 v176, v176
  v_exp_f32 v177, v177
  v_exp_f32 v178, v178
  v_exp_f32 v179, v179
  v_exp_f32 v180, v180
  v_mfma_f32_32x32x16_bf16 v[128:143], v[60:63], v[160:163], v[128:143]
  v_exp_f32 v181, v181
  v_exp_f32 v182, v182
  v_exp_f32 v183, v183
  v_exp_f32 v184, v184
  v_exp_f32 v185, v185
  v_mfma_f32_32x32x16_bf16 v[128:143], v[64:67], v[164:167], v[128:143]
  v_exp_f32 v186, v186
  v_exp_f32 v187, v187
  v_exp_f32 v188, v188
  v_exp_f32 v189, v189
  v_exp_f32 v190, v190
  v_exp_f32 v191, v191
  v_cvt_pk_bf16_f32 v176, v176, v177
  v_cvt_pk_bf16_f32 v177, v178, v179
  v_cvt_pk_bf16_f32 v178, v180, v181
  v_cvt_pk_bf16_f32 v179, v182, v183
  v_cvt_pk_bf16_f32 v180, v184, v185
  v_cvt_pk_bf16_f32 v181, v186, v187
  v_cvt_pk_bf16_f32 v182, v188, v189
  v_cvt_pk_bf16_f32 v183, v190, v191
  v_bfi_b32 v176, v232, 0, v176
  v_bfi_b32 v177, v233, 0, v177
  v_bfi_b32 v178, v234, 0, v178
  v_bfi_b32 v179, v235, 0, v179
  v_bfi_b32 v180, v236, 0, v180
  v_bfi_b32 v181, v237, 0, v181
  v_bfi_b32 v182, v238, 0, v182
  v_bfi_b32 v183, v239, 0, v183
  v_mfma_f32_32x32x16_bf16 v[144:159], v[72:75], v[176:179], v[144:159]
  v_exp_f32 v192, v192
  v_exp_f32 v193, v193
  v_exp_f32 v194, v194
  v_exp_f32 v195, v195
  v_exp_f32 v196, v196
  v_mfma_f32_32x32x16_bf16 v[144:159], v[76:79], v[180:183], v[144:159]
  v_exp_f32 v197, v197
  v_exp_f32 v198, v198
  v_exp_f32 v199, v199
  v_exp_f32 v200, v200
  v_exp_f32 v201, v201
  v_exp_f32 v202, v202
  v_exp_f32 v203, v203
  v_exp_f32 v204, v204
  v_exp_f32 v205, v205
  v_exp_f32 v206, v206
  v_exp_f32 v207, v207
  v_cvt_pk_bf16_f32 v192, v192, v193
  v_cvt_pk_bf16_f32 v193, v194, v195
  v_cvt_pk_bf16_f32 v194, v196, v197
  v_cvt_pk_bf16_f32 v195, v198, v199
  v_cvt_pk_bf16_f32 v196, v200, v201
  v_cvt_pk_bf16_f32 v197, v202, v203
  v_cvt_pk_bf16_f32 v198, v204, v205
  v_cvt_pk_bf16_f32 v199, v206, v207
  v_mfma_f32_32x32x16_bf16 v[144:159], v[60:63], v[192:195], v[144:159]
  s_nop 0
  v_mfma_f32_32x32x16_bf16 v[144:159], v[64:67], v[196:199], v[144:159]
  s_cmp_eq_u32 s17, 0
  s_cbranch_scc1 L_s_62
  v_mfma_f32_32x32x16_bf16 v[160:175], v[44:47], v[88:91], v[96:111]
  v_mfma_f32_32x32x16_bf16 v[176:191], v[32:35], v[88:91], v[96:111]
  s_nop 10
  v_exp_f32 v160, v160
  v_exp_f32 v161, v161
  v_exp_f32 v162, v162
  v_exp_f32 v163, v163
  v_exp_f32 v164, v164
  v_exp_f32 v165, v165
  v_exp_f32 v166, v166
  v_exp_f32 v167, v167
  v_exp_f32 v168, v168
  v_exp_f32 v169, v169
  v_exp_f32 v170, v170
  v_exp_f32 v171, v171
  v_exp_f32 v172, v172
  v_exp_f32 v173, v173
  v_exp_f32 v174, v174
  v_exp_f32 v175, v175
  v_cvt_pk_bf16_f32 v160, v160, v161
  v_cvt_pk_bf16_f32 v161, v162, v163
  v_cvt_pk_bf16_f32 v162, v164, v165
  v_cvt_pk_bf16_f32 v163, v166, v167
  v_cvt_pk_bf16_f32 v164, v168, v169
  v_cvt_pk_bf16_f32 v165, v170, v171
  v_cvt_pk_bf16_f32 v166, v172, v173
  v_cvt_pk_bf16_f32 v167, v174, v175
  v_mfma_f32_32x32x16_bf16 v[192:207], v[44:47], v[92:95], v[112:127]
  v_exp_f32 v176, v176
  v_exp_f32 v177, v177
  v_exp_f32 v178, v178
  v_exp_f32 v179, v179
  v_exp_f32 v180, v180
  v_mfma_f32_32x32x16_bf16 v[128:143], v[48:51], v[160:163], v[128:143]
  v_exp_f32 v181, v181
  v_exp_f32 v182, v182
  v_exp_f32 v183, v183
  v_exp_f32 v184, v184
  v_exp_f32 v185, v185
  v_mfma_f32_32x32x16_bf16 v[128:143], v[52:55], v[164:167], v[128:143]
  v_exp_f32 v186, v186
  v_exp_f32 v187, v187
  v_exp_f32 v188, v188
  v_exp_f32 v189, v189
  v_exp_f32 v190, v190
  v_exp_f32 v191, v191
  v_cvt_pk_bf16_f32 v176, v176, v177
  v_cvt_pk_bf16_f32 v177, v178, v179
  v_cvt_pk_bf16_f32 v178, v180, v181
  v_cvt_pk_bf16_f32 v179, v182, v183
  v_cvt_pk_bf16_f32 v180, v184, v185
  v_cvt_pk_bf16_f32 v181, v186, v187
  v_cvt_pk_bf16_f32 v182, v188, v189
  v_cvt_pk_bf16_f32 v183, v190, v191
  v_and_b32 v176, v176, v232
  v_and_b32 v177, v177, v233
  v_and_b32 v178, v178, v234
  v_and_b32 v179, v179, v235
  v_and_b32 v180, v180, v236
  v_and_b32 v181, v181, v237
  v_and_b32 v182, v182, v238
  v_and_b32 v183, v183, v239
  v_mfma_f32_32x32x16_bf16 v[128:143], v[36:39], v[176:179], v[128:143]
  v_exp_f32 v192, v192
  v_exp_f32 v193, v193
  v_exp_f32 v194, v194
  v_exp_f32 v195, v195
  v_exp_f32 v196, v196
  v_mfma_f32_32x32x16_bf16 v[128:143], v[40:43], v[180:183], v[128:143]
  v_exp_f32 v197, v197
  v_exp_f32 v198, v198
  v_exp_f32 v199, v199
  v_exp_f32 v200, v200
  v_exp_f32 v201, v201
  v_exp_f32 v202, v202
  v_exp_f32 v203, v203
  v_exp_f32 v204, v204
  v_exp_f32 v205, v205
  v_exp_f32 v206, v206
  v_exp_f32 v207, v207
  v_cvt_pk_bf16_f32 v192, v192, v193
  v_cvt_pk_bf16_f32 v193, v194, v195
  v_cvt_pk_bf16_f32 v194, v196, v197
  v_cvt_pk_bf16_f32 v195, v198, v199
  v_cvt_pk_bf16_f32 v196, v200, v201
  v_cvt_pk_bf16_f32 v197, v202, v203
  v_cvt_pk_bf16_f32 v198, v204, v205
  v_cvt_pk_bf16_f32 v199, v206, v207
  v_and_b32 v192, v192, v232
  v_and_b32 v193, v193, v233
  v_and_b32 v194, v194, v234
  v_and_b32 v195, v195, v235
  v_and_b32 v196, v196, v236
  v_and_b32 v197, v197, v237
  v_and_b32 v198, v198, v238
  v_and_b32 v199, v199, v239
  v_mfma_f32_32x32x16_bf16 v[144:159], v[48:51], v[192:195], v[144:159]
  s_nop 0
  v_mfma_f32_32x32x16_bf16 v[144:159], v[52:55], v[196:199], v[144:159]
L_s_62:
  s_cmp_ge_u32 s85, 43
  s_cbranch_scc1 L_nwd_63
  s_lshl_b32 s37, s85, 15
  s_lshl_b32 s20, s14, 8
  s_add_u32 s37, s37, s20
  v_lshrrev_b32 v2, 4, v1
  v_and_b32 v3, 15, v1
  v_lshlrev_b32 v3, 4, v3
  v_lshl_add_u32 v2, v2, 10, v3
  buffer_load_dwordx4 v[96:99], v2, s[76:79], s37 offen nt
  s_add_u32 s37, s37, 4096
  buffer_load_dwordx4 v[100:103], v2, s[76:79], s37 offen nt
  s_add_u32 s37, s37, 4096
  buffer_load_dwordx4 v[104:107], v2, s[76:79], s37 offen nt
  s_add_u32 s37, s37, 4096
  buffer_load_dwordx4 v[108:111], v2, s[76:79], s37 offen nt
  s_add_u32 s37, s37, 4096
  buffer_load_dwordx4 v[112:115], v2, s[76:79], s37 offen nt
  s_add_u32 s37, s37, 4096
  buffer_load_dwordx4 v[116:119], v2, s[76:79], s37 offen nt
  s_add_u32 s37, s37, 4096
  buffer_load_dwordx4 v[120:123], v2, s[76:79], s37 offen nt
  s_add_u32 s37, s37, 4096
  buffer_load_dwordx4 v[124:127], v2, s[76:79], s37 offen nt
  s_add_u32 s37, s37, 4096
L_nwd_63:
  s_waitcnt vmcnt(0)
  s_branch L_p2done
.section .rodata,"a"
.p2align 6
.amdhsa_kernel parallel_sum__sliding_block__moe_arch_mod__prompt_kernel
  .amdhsa_next_free_vgpr 256
  .amdhsa_next_free_sgpr 102
  .amdhsa_accum_offset 256
  .amdhsa_group_segment_fixed_size 0
  .amdhsa_kernarg_size 88
  .amdhsa_user_sgpr_count 2
  .amdhsa_user_sgpr_kernarg_segment_ptr 1
  .amdhsa_system_sgpr_workgroup_id_x 1
  .amdhsa_float_denorm_mode_32 3
.end_amdhsa_kernel
```
